```python
import torch

def _softmax(x, axis=-1):
    return torch.softmax(x, dim=axis)
def _gelu(x):
    return torch.nn.functional.gelu(x, approximate="tanh")
def _silu(x):
    return torch.nn.functional.silu(x)
def _sigmoid(x):
    return torch.sigmoid(x)
def _layernorm(x, axis=-1, eps=1e-5):
    m = x.mean(dim=axis, keepdim=True)
    v = x.var(dim=axis, keepdim=True, unbiased=False)
    return (x - m) / torch.sqrt(v + eps)
def _scatter_add(tgt, idx, src, axis=0):
    return tgt.clone().index_add_(axis, idx, src)
def _segment_sum(src, seg, n):
    out = torch.zeros((n,) + src.shape[1:], dtype=src.dtype)
    return out.index_add_(0, seg, src)
def _pad(x, pw):
    flat = tuple(v for pair in reversed(pw) for v in pair)
    return torch.nn.functional.pad(x, flat)

kernel_name = 'gated_mix__grouped_kv_mqa__geglu_ffn__prompt'

def setup_inputs():

    _w = (lambda a: (lambda t: t.to(torch.bfloat16) if t.is_floating_point() else t)(torch.as_tensor(a)))
    def _A_setup():
        B, S, D, H = 1, 2048, 512, 32
        Dh = D // H
        return {
            "x": _w((lambda *s: torch.randn(*s, dtype=torch.bfloat16) * 0.05)(B, S, D)),
            "wq": _w((lambda *s: torch.randn(*s, dtype=torch.bfloat16) * 0.8)(D, H * Dh)),
            "wk": _w((lambda *s: torch.randn(*s, dtype=torch.bfloat16) * 0.8)(D, Dh)),
            "wv": _w((lambda *s: torch.randn(*s, dtype=torch.bfloat16) * 0.05)(D, Dh)),
            "wo": _w((lambda *s: torch.randn(*s, dtype=torch.bfloat16) * 0.05)(H * Dh, D)),
        }
    _A_in = _A_setup()

    def _B_setup():
        B, S, D, F = 1, 2048, 512, 1376
        return {
            "x": _w((lambda *s: torch.randn(*s, dtype=torch.bfloat16) * 0.05)(B, S, D)),
            "w_gate": _w((lambda *s: torch.randn(*s, dtype=torch.bfloat16) * 0.05)(D, F)),
            "w_up": _w((lambda *s: torch.randn(*s, dtype=torch.bfloat16) * 0.05)(D, F)),
            "w_down": _w((lambda *s: torch.randn(*s, dtype=torch.bfloat16) * 0.05)(F, D)),
        }
    _B_in = _B_setup()

    return {
        "A_x": _A_in["x"],
        "A_wq": _A_in["wq"],
        "A_wk": _A_in["wk"],
        "A_wv": _A_in["wv"],
        "A_wo": _A_in["wo"],
        "B_x": _B_in["x"],
        "B_w_gate": _B_in["w_gate"],
        "B_w_up": _B_in["w_up"],
        "B_w_down": _B_in["w_down"],
        "gate_w": _w((lambda *s: torch.randn(*s, dtype=torch.bfloat16) * 0.05)(512) * 16.0),
    }

def reference(A_x, A_wq, A_wk, A_wv, A_wo, B_x, B_w_gate, B_w_up, B_w_down, gate_w):
    def _A_ref(x, wq, wk, wv, wo):
        B, S, D = x.shape
        H = 32
        Dh = D // H
        q = (lambda x, *d: x.permute(*d))((x @ wq).reshape(B, S, H, Dh), 0, 2, 1, 3)
        k = x @ wk
        v = x @ wv
        scores = torch.einsum("bhqd,bkd->bhqk", q, k) * (Dh ** -0.5)
        p = _softmax(scores, axis=-1)
        o = torch.einsum("bhqk,bkd->bhqd", p, v)
        return (lambda x, *d: x.permute(*d))(o, 0, 2, 1, 3).reshape(B, S, H * Dh) @ wo

    def _B_ref(x, w_gate, w_up, w_down):
        return (_gelu(x @ w_gate) * (x @ w_up)) @ w_down

    x = A_x
    g = _sigmoid((x * gate_w).sum(-1, keepdims=True))
    a = _A_ref(x, A_wq, A_wk, A_wv, A_wo)
    b = _B_ref(x, B_w_gate, B_w_up, B_w_down)
    return g * a + (1 - g) * b
```

```asm
; @launch grid=(256,1,1) block=(512,1,1) lds=160640
.amdgcn_target "amdgcn-amd-amdhsa--gfx950"
.text
.globl gated_mix__grouped_kv_mqa__geglu_ffn__prompt_kernel
.p2align 8
.type gated_mix__grouped_kv_mqa__geglu_ffn__prompt_kernel,@function
gated_mix__grouped_kv_mqa__geglu_ffn__prompt_kernel:
    s_load_dwordx16 s[56:71], s[0:1], 0
    s_load_dwordx8 s[72:79], s[0:1], 64
    s_load_dwordx2 s[80:81], s[0:1], 96
    s_cmp_ge_u32 s2, 256
    s_cbranch_scc1 M_end
    v_lshrrev_b32 v2, 6, v0
    v_and_b32 v1, 63, v0
    v_readfirstlane_b32 s3, v2
    s_and_b32 s4, s2, 7
    s_lshr_b32 s5, s2, 6
    s_lshl_b32 s5, s5, 3
    s_add_u32 s4, s4, s5
    s_bfe_u32 s5, s2, 0x30003
    s_mov_b32 s98, 0x800000
    s_mov_b32 s99, 0
    v_mov_b32 v20, 160256
    v_lshl_add_u32 v2, v1, 2, v20
    v_mov_b32 v3, 0
    s_mov_b32 exec_hi, 0
    ds_write_b32 v2, v3
    s_mov_b32 exec_hi, -1
    v_lshlrev_b32 v4, 4, v1
    s_cmp_lt_u32 s3, 4
    s_cbranch_scc1 M_A
    s_sub_u32 s33, s3, 4
    v_lshrrev_b32 v2, 3, v1
    v_and_b32 v3, 7, v1
    v_lshrrev_b32 v6, 1, v2
    v_xor_b32 v6, v6, v3
    v_lshlrev_b32 v6, 4, v6
    v_lshl_add_u32 v7, v2, 10, v6
    v_xor_b32 v8, 64, v7
    s_and_b32 s55, s5, 3
    s_add_u32 s6, s55, s33
    s_and_b32 s6, s6, 3
    s_lshl_b32 s48, s6, 14
    s_lshl_b32 s49, s6, 11
    s_add_u32 s46, s48, 8192
    s_lshl_b32 s7, s33, 10
    s_lshl_b32 s6, s4, 16
    v_mov_b32 v21, 1
    s_mov_b32 m0, 65536
    s_waitcnt lgkmcnt(0)
    s_add_u32 s8, s56, s6
    s_addc_u32 s9, s57, 0
    s_mov_b32 s10, 65536
    s_mov_b32 s11, 0x20000
    s_cmp_lg_u32 s33, 0
    s_cbranch_scc1 F_xwait
    s_cmp_ge_u32 s5, 4
    s_cselect_b32 s34, s62, s60
    s_cselect_b32 s35, s63, s61
    s_mov_b32 s16, s34
    s_mov_b32 s17, s35
    s_mov_b32 s18, 16384
    s_mov_b32 s19, 0x20000
    buffer_load_dwordx4 v4, s[16:19], 0 offen offset:0 lds
    buffer_load_dwordx4 v4, s[16:19], 0 offen offset:1024 lds
    buffer_load_dwordx4 v4, s[16:19], 0 offen offset:2048 lds
    buffer_load_dwordx4 v4, s[16:19], 0 offen offset:3072 lds
    s_mov_b32 m0, 69632
    s_movk_i32 s40, 4096
    buffer_load_dwordx4 v4, s[16:19], s40 offen offset:0 lds
    buffer_load_dwordx4 v4, s[16:19], s40 offen offset:1024 lds
    buffer_load_dwordx4 v4, s[16:19], s40 offen offset:2048 lds
    buffer_load_dwordx4 v4, s[16:19], s40 offen offset:3072 lds
    s_mov_b32 m0, 73728
    s_movk_i32 s40, 8192
    buffer_load_dwordx4 v4, s[16:19], s40 offen offset:0 lds
    buffer_load_dwordx4 v4, s[16:19], s40 offen offset:1024 lds
    buffer_load_dwordx4 v4, s[16:19], s40 offen offset:2048 lds
    buffer_load_dwordx4 v4, s[16:19], s40 offen offset:3072 lds
    s_mov_b32 m0, 77824
    s_movk_i32 s40, 12288
    buffer_load_dwordx4 v4, s[16:19], s40 offen offset:0 lds
    buffer_load_dwordx4 v4, s[16:19], s40 offen offset:1024 lds
    buffer_load_dwordx4 v4, s[16:19], s40 offen offset:2048 lds
    buffer_load_dwordx4 v4, s[16:19], s40 offen offset:3072 lds
    s_mov_b32 m0, 81920
    s_mov_b32 s20, s74
    s_mov_b32 s21, s75
    s_mov_b32 s22, 1024
    s_mov_b32 s23, 0x20000
    buffer_load_dwordx4 v4, s[20:23], 0 offen lds
    s_branch F_xgo
F_xwait:
    s_barrier
F_xgo:
    s_add_u32 s6, s5, 0
    s_and_b32 s6, s6, 7
    s_lshl_b32 s47, s6, 13
    s_add_u32 s47, s47, s49
    s_mov_b32 m0, s47
    s_lshl_b32 s6, s6, 7
    s_add_u32 s45, s6, s48
    buffer_load_dwordx4 v7, s[8:11], s45 offen lds
    s_add_u32 m0, s47, 1024
    s_add_u32 s45, s6, s46
    buffer_load_dwordx4 v8, s[8:11], s45 offen lds
    s_add_u32 s6, s5, 1
    s_and_b32 s6, s6, 7
    s_lshl_b32 s47, s6, 13
    s_add_u32 s47, s47, s49
    s_mov_b32 m0, s47
    s_lshl_b32 s6, s6, 7
    s_add_u32 s45, s6, s48
    buffer_load_dwordx4 v7, s[8:11], s45 offen lds
    s_add_u32 m0, s47, 1024
    s_add_u32 s45, s6, s46
    buffer_load_dwordx4 v8, s[8:11], s45 offen lds
    s_add_u32 s6, s5, 2
    s_and_b32 s6, s6, 7
    s_lshl_b32 s47, s6, 13
    s_add_u32 s47, s47, s49
    s_mov_b32 m0, s47
    s_lshl_b32 s6, s6, 7
    s_add_u32 s45, s6, s48
    buffer_load_dwordx4 v7, s[8:11], s45 offen lds
    s_add_u32 m0, s47, 1024
    s_add_u32 s45, s6, s46
    buffer_load_dwordx4 v8, s[8:11], s45 offen lds
    s_add_u32 s6, s5, 3
    s_and_b32 s6, s6, 7
    s_lshl_b32 s47, s6, 13
    s_add_u32 s47, s47, s49
    s_mov_b32 m0, s47
    s_lshl_b32 s6, s6, 7
    s_add_u32 s45, s6, s48
    buffer_load_dwordx4 v7, s[8:11], s45 offen lds
    s_add_u32 m0, s47, 1024
    s_add_u32 s45, s6, s46
    buffer_load_dwordx4 v8, s[8:11], s45 offen lds
    s_add_u32 s6, s5, 4
    s_and_b32 s6, s6, 7
    s_lshl_b32 s47, s6, 13
    s_add_u32 s47, s47, s49
    s_mov_b32 m0, s47
    s_lshl_b32 s6, s6, 7
    s_add_u32 s45, s6, s48
    buffer_load_dwordx4 v7, s[8:11], s45 offen lds
    s_add_u32 m0, s47, 1024
    s_add_u32 s45, s6, s46
    buffer_load_dwordx4 v8, s[8:11], s45 offen lds
    s_add_u32 s6, s5, 5
    s_and_b32 s6, s6, 7
    s_lshl_b32 s47, s6, 13
    s_add_u32 s47, s47, s49
    s_mov_b32 m0, s47
    s_lshl_b32 s6, s6, 7
    s_add_u32 s45, s6, s48
    buffer_load_dwordx4 v7, s[8:11], s45 offen lds
    s_add_u32 m0, s47, 1024
    s_add_u32 s45, s6, s46
    buffer_load_dwordx4 v8, s[8:11], s45 offen lds
    s_add_u32 s6, s5, 6
    s_and_b32 s6, s6, 7
    s_lshl_b32 s47, s6, 13
    s_add_u32 s47, s47, s49
    s_mov_b32 m0, s47
    s_lshl_b32 s6, s6, 7
    s_add_u32 s45, s6, s48
    buffer_load_dwordx4 v7, s[8:11], s45 offen lds
    s_add_u32 m0, s47, 1024
    s_add_u32 s45, s6, s46
    buffer_load_dwordx4 v8, s[8:11], s45 offen lds
    s_add_u32 s6, s5, 7
    s_and_b32 s6, s6, 7
    s_lshl_b32 s47, s6, 13
    s_add_u32 s47, s47, s49
    s_mov_b32 m0, s47
    s_lshl_b32 s6, s6, 7
    s_add_u32 s45, s6, s48
    buffer_load_dwordx4 v7, s[8:11], s45 offen lds
    s_add_u32 m0, s47, 1024
    s_add_u32 s45, s6, s46
    buffer_load_dwordx4 v8, s[8:11], s45 offen lds
    s_cmp_lg_u32 s33, 0
    s_cbranch_scc1 F_oth
    s_mov_b32 s28, s78
    s_mov_b32 s29, s79
    s_mov_b32 s30, 256
    s_mov_b32 s31, 0x20000
    v_mov_b32 v5, 0
    buffer_load_dword v220, v5, s[28:31], 0 offen offset:128 sc1
    s_barrier
    v_lshrrev_b32 v2, 3, v1
    v_and_b32 v3, 7, v1
    v_bfe_u32 v6, v2, 1, 1
    v_lshlrev_b32 v6, 2, v6
    v_xor_b32 v6, v6, v3
    v_lshlrev_b32 v6, 4, v6
    v_lshl_add_u32 v23, v2, 10, v6
    s_lshl_b32 s6, s5, 7
    v_add_u32 v23, s6, v23
    s_mul_i32 s44, s5, 352
    s_movk_i32 s46, 2400
    s_lshl_b32 s45, s33, 6
    s_add_u32 s34, s7, 65536
    s_add_u32 s35, s34, 4096
    s_add_u32 s37, s34, 12416
    s_add_u32 s38, s34, 16512
    s_cmp_eq_u32 s33, 3
    s_cselect_b32 s6, 128, 0
    s_cselect_b32 s42, 704, 0
    s_sub_u32 s42, 512, s42
    s_add_u32 s36, s34, s6
    s_add_u32 s36, s36, 8192
    s_cmp_ge_u32 s33, 2
    s_cselect_b32 s6, 0, 20608
    s_cselect_b32 s43, 0, 576
    s_add_u32 s39, s34, s6
    s_cmp_ge_u32 s33, 2
    s_cselect_b32 s39, 163840, s39
    v_add_u32 v5, s45, v1
    v_add_u32 v2, 0, v5
    v_mul_u32_u24 v3, 2979, v2
    v_lshrrev_b32 v3, 16, v3
    v_lshl_add_u32 v2, v2, 4, s44
    v_mad_u32_u24 v8, v3, s46, v2
    v_add_u32 v2, 256, v5
    v_mul_u32_u24 v3, 2979, v2
    v_lshrrev_b32 v3, 16, v3
    v_lshl_add_u32 v2, v2, 4, s44
    v_mad_u32_u24 v9, v3, s46, v2
    v_add_u32 v2, s42, v5
    v_mul_u32_u24 v3, 2979, v2
    v_lshrrev_b32 v3, 16, v3
    v_lshl_add_u32 v2, v2, 4, s44
    v_mad_u32_u24 v10, v3, s46, v2
    v_add_u32 v2, 64, v5
    v_mul_u32_u24 v3, 2979, v2
    v_lshrrev_b32 v3, 16, v3
    v_lshl_add_u32 v2, v2, 4, s44
    v_mad_u32_u24 v11, v3, s46, v2
    v_add_u32 v2, 320, v5
    v_mul_u32_u24 v3, 2979, v2
    v_lshrrev_b32 v3, 16, v3
    v_lshl_add_u32 v2, v2, 4, s44
    v_mad_u32_u24 v12, v3, s46, v2
    v_add_u32 v2, s43, v5
    v_mul_u32_u24 v3, 2979, v2
    v_lshrrev_b32 v3, 16, v3
    v_lshl_add_u32 v2, v2, 4, s44
    v_mad_u32_u24 v13, v3, s46, v2
    v_and_b32 v2, 31, v1
    v_lshrrev_b32 v3, 5, v1
    v_bfe_u32 v5, v2, 1, 3
    v_lshlrev_b32 v2, 7, v2
    v_or_b32 v6, 0, v3
    v_xor_b32 v6, v6, v5
    v_lshl_add_u32 v14, v6, 4, v2
    v_or_b32 v6, 2, v3
    v_xor_b32 v6, v6, v5
    v_lshl_add_u32 v15, v6, 4, v2
    v_or_b32 v6, 4, v3
    v_xor_b32 v6, v6, v5
    v_lshl_add_u32 v16, v6, 4, v2
    v_or_b32 v6, 6, v3
    v_xor_b32 v6, v6, v5
    v_lshl_add_u32 v17, v6, 4, v2
    v_bfe_u32 v2, v1, 2, 2
    v_lshl_add_u32 v2, v3, 3, v2
    v_mul_u32_u24 v2, 352, v2
    v_bfe_u32 v3, v1, 4, 1
    v_mul_u32_u24 v3, 11392, v3
    v_add_u32 v2, v2, v3
    v_and_b32 v3, 3, v1
    v_lshl_add_u32 v2, v3, 3, v2
    s_lshl_b32 s6, s33, 5
    s_add_u32 s6, s6, 65536
    v_add_u32 v18, s6, v2
    v_add_u32 v19, 45312, v18
    s_mov_b32 s47, 0
    s_mov_b32 s12, s68
    s_mov_b32 s13, s69
    s_mov_b32 s14, 1409024
    s_mov_b32 s15, 0x20000
    s_mov_b32 s16, s70
    s_mov_b32 s17, s71
    s_mov_b32 s18, 1409024
    s_mov_b32 s19, 0x20000
    s_cmp_eq_u32 s33, 3
    s_cselect_b32 s42, s70, s68
    s_cselect_b32 s43, s71, s69
    s_mov_b32 s20, s42
    s_mov_b32 s21, s43
    s_mov_b32 s22, 1409024
    s_mov_b32 s23, 0x20000
    s_cmp_ge_u32 s33, 2
    s_cselect_b32 s42, s68, s70
    s_cselect_b32 s43, s69, s71
    s_mov_b32 s24, s42
    s_mov_b32 s25, s43
    s_mov_b32 s26, 1409024
    s_mov_b32 s27, 0x20000
    s_cselect_b32 s26, 0, s26
    s_lshl_b32 s6, s55, 4
    v_and_b32 v205, 15, v1
    v_add_u32 v200, s6, v205
    v_lshrrev_b32 v206, 4, v1
    v_bfe_u32 v5, v200, 1, 3
    v_xor_b32 v5, v5, v206
    v_lshlrev_b32 v5, 4, v5
    v_lshl_add_u32 v201, v200, 7, v5
    v_xor_b32 v202, 64, v201
    v_bfe_u32 v5, v1, 2, 2
    v_lshl_add_u32 v5, v206, 3, v5
    v_lshlrev_b32 v5, 5, v5
    v_and_b32 v6, 3, v1
    v_lshl_add_u32 v5, v6, 3, v5
    v_add_u32 v203, 65536, v5
    s_and_b32 s53, s4, 3
    s_lshr_b32 s6, s4, 3
    s_lshl_b32 s6, s6, 2
    s_add_u32 s53, s53, s6
    s_bfe_u32 s6, s4, 0x10002
    s_lshl_b32 s6, s6, 4
    s_add_u32 s53, s53, s6
    s_waitcnt vmcnt(1)
    s_mov_b64 exec, 1
    ds_add_u32 v20, v21 offset:60
    s_mov_b64 exec, -1
    s_add_u32 s28, s80, 4194304
    s_addc_u32 s29, s81, 0
    s_mov_b32 s30, 205312
    s_mov_b32 s31, 0x20000
    s_cmp_ge_u32 s5, 4
    s_cbranch_scc1 F_v
    ds_read_b128 v[24:27], v201 offset:0
    ds_read_b64_tr_b16 v[28:29], v203 offset:0
    ds_read_b64_tr_b16 v[30:31], v203 offset:128
    ds_read_b128 v[32:35], v202 offset:0
    ds_read_b64_tr_b16 v[36:37], v203 offset:1024
    ds_read_b64_tr_b16 v[38:39], v203 offset:1152
    ds_read_b128 v[40:43], v201 offset:8192
    ds_read_b64_tr_b16 v[44:45], v203 offset:2048
    ds_read_b64_tr_b16 v[46:47], v203 offset:2176
    ds_read_b128 v[48:51], v202 offset:8192
    ds_read_b64_tr_b16 v[52:53], v203 offset:3072
    ds_read_b64_tr_b16 v[54:55], v203 offset:3200
    ds_read_b128 v[56:59], v201 offset:16384
    ds_read_b64_tr_b16 v[60:61], v203 offset:4096
    ds_read_b64_tr_b16 v[62:63], v203 offset:4224
    s_waitcnt lgkmcnt(12)
    v_mfma_f32_16x16x32_bf16 v[208:211], v[28:31], v[24:27], 0
    ds_read_b128 v[64:67], v202 offset:16384
    ds_read_b64_tr_b16 v[68:69], v203 offset:5120
    ds_read_b64_tr_b16 v[70:71], v203 offset:5248
    s_waitcnt lgkmcnt(12)
    v_mfma_f32_16x16x32_bf16 v[208:211], v[36:39], v[32:35], v[208:211]
    ds_read_b128 v[24:27], v201 offset:24576
    ds_read_b64_tr_b16 v[28:29], v203 offset:6144
    ds_read_b64_tr_b16 v[30:31], v203 offset:6272
    s_waitcnt lgkmcnt(12)
    v_mfma_f32_16x16x32_bf16 v[208:211], v[44:47], v[40:43], v[208:211]
    ds_read_b128 v[32:35], v202 offset:24576
    ds_read_b64_tr_b16 v[36:37], v203 offset:7168
    ds_read_b64_tr_b16 v[38:39], v203 offset:7296
    s_waitcnt lgkmcnt(12)
    v_mfma_f32_16x16x32_bf16 v[208:211], v[52:55], v[48:51], v[208:211]
    ds_read_b128 v[40:43], v201 offset:32768
    ds_read_b64_tr_b16 v[44:45], v203 offset:8192
    ds_read_b64_tr_b16 v[46:47], v203 offset:8320
    s_waitcnt lgkmcnt(12)
    v_mfma_f32_16x16x32_bf16 v[208:211], v[60:63], v[56:59], v[208:211]
    ds_read_b128 v[48:51], v202 offset:32768
    ds_read_b64_tr_b16 v[52:53], v203 offset:9216
    ds_read_b64_tr_b16 v[54:55], v203 offset:9344
    s_waitcnt lgkmcnt(12)
    v_mfma_f32_16x16x32_bf16 v[208:211], v[68:71], v[64:67], v[208:211]
    ds_read_b128 v[56:59], v201 offset:40960
    ds_read_b64_tr_b16 v[60:61], v203 offset:10240
    ds_read_b64_tr_b16 v[62:63], v203 offset:10368
    s_waitcnt lgkmcnt(12)
    v_mfma_f32_16x16x32_bf16 v[208:211], v[28:31], v[24:27], v[208:211]
    ds_read_b128 v[64:67], v202 offset:40960
    ds_read_b64_tr_b16 v[68:69], v203 offset:11264
    ds_read_b64_tr_b16 v[70:71], v203 offset:11392
    s_waitcnt lgkmcnt(12)
    v_mfma_f32_16x16x32_bf16 v[208:211], v[36:39], v[32:35], v[208:211]
    ds_read_b128 v[24:27], v201 offset:49152
    ds_read_b64_tr_b16 v[28:29], v203 offset:12288
    ds_read_b64_tr_b16 v[30:31], v203 offset:12416
    s_waitcnt lgkmcnt(12)
    v_mfma_f32_16x16x32_bf16 v[208:211], v[44:47], v[40:43], v[208:211]
    ds_read_b128 v[32:35], v202 offset:49152
    ds_read_b64_tr_b16 v[36:37], v203 offset:13312
    ds_read_b64_tr_b16 v[38:39], v203 offset:13440
    s_waitcnt lgkmcnt(12)
    v_mfma_f32_16x16x32_bf16 v[208:211], v[52:55], v[48:51], v[208:211]
    ds_read_b128 v[40:43], v201 offset:57344
    ds_read_b64_tr_b16 v[44:45], v203 offset:14336
    ds_read_b64_tr_b16 v[46:47], v203 offset:14464
    s_waitcnt lgkmcnt(12)
    v_mfma_f32_16x16x32_bf16 v[208:211], v[60:63], v[56:59], v[208:211]
    ds_read_b128 v[48:51], v202 offset:57344
    ds_read_b64_tr_b16 v[52:53], v203 offset:15360
    ds_read_b64_tr_b16 v[54:55], v203 offset:15488
    s_waitcnt lgkmcnt(12)
    v_mfma_f32_16x16x32_bf16 v[208:211], v[68:71], v[64:67], v[208:211]
    s_waitcnt lgkmcnt(9)
    v_mfma_f32_16x16x32_bf16 v[208:211], v[28:31], v[24:27], v[208:211]
    s_waitcnt lgkmcnt(6)
    v_mfma_f32_16x16x32_bf16 v[208:211], v[36:39], v[32:35], v[208:211]
    s_waitcnt lgkmcnt(3)
    v_mfma_f32_16x16x32_bf16 v[208:211], v[44:47], v[40:43], v[208:211]
    s_waitcnt lgkmcnt(0)
    v_mfma_f32_16x16x32_bf16 v[208:211], v[52:55], v[48:51], v[208:211]
    s_mul_i32 s6, s53, 4352
    v_lshrrev_b32 v5, 5, v200
    v_lshlrev_b32 v5, 10, v5
    v_and_b32 v6, 31, v200
    v_lshl_add_u32 v5, v6, 4, v5
    v_and_b32 v6, 1, v206
    v_lshl_add_u32 v5, v6, 9, v5
    v_lshrrev_b32 v6, 1, v206
    v_lshl_add_u32 v5, v6, 3, v5
    s_mov_b32 s43, 0x3eb8aa3b
    v_mul_f32 v208, s43, v208
    v_mul_f32 v209, s43, v209
    v_mul_f32 v210, s43, v210
    v_mul_f32 v211, s43, v211
    v_cvt_pk_bf16_f32 v216, v208, v209
    v_cvt_pk_bf16_f32 v217, v210, v211
    buffer_store_dwordx2 v[216:217], v5, s[28:31], s6 offen sc1
    v_mul_f32 v6, v208, v208
    v_fmac_f32 v6, v209, v209
    v_fmac_f32 v6, v210, v210
    v_fmac_f32 v6, v211, v211
    v_mov_b32 v5, v6
    s_lshl_b32 s6, s53, 2
    s_add_u32 s6, s6, s55
    v_permlane32_swap_b32 v6, v5
    s_lshl_b32 s6, s6, 2
    s_add_u32 s6, s6, 204800
    v_add_f32 v6, v6, v5
    v_mov_b32 v5, v6
    s_nop 1
    v_permlane16_swap_b32 v6, v5
    s_nop 1
    v_add_f32 v6, v6, v5
    v_mov_b32 v5, 0
    s_nop 1
    v_max_u32_dpp v6, v6, v6 row_ror:8 row_mask:0xf bank_mask:0xf
    s_nop 1
    v_max_u32_dpp v6, v6, v6 row_ror:4 row_mask:0xf bank_mask:0xf
    s_nop 1
    v_max_u32_dpp v6, v6, v6 row_ror:2 row_mask:0xf bank_mask:0xf
    s_nop 1
    v_max_u32_dpp v6, v6, v6 row_ror:1 row_mask:0xf bank_mask:0xf
    s_mov_b64 exec, 1
    buffer_store_dword v6, v5, s[28:31], s6 offen sc1
    s_mov_b64 exec, -1
    s_branch F_kvjoin
F_v:
    ds_read_b128 v[24:27], v201 offset:0
    ds_read_b64_tr_b16 v[28:29], v203 offset:0
    ds_read_b64_tr_b16 v[30:31], v203 offset:128
    ds_read_b128 v[32:35], v202 offset:0
    ds_read_b64_tr_b16 v[36:37], v203 offset:1024
    ds_read_b64_tr_b16 v[38:39], v203 offset:1152
    ds_read_b128 v[40:43], v201 offset:8192
    ds_read_b64_tr_b16 v[44:45], v203 offset:2048
    ds_read_b64_tr_b16 v[46:47], v203 offset:2176
    ds_read_b128 v[48:51], v202 offset:8192
    ds_read_b64_tr_b16 v[52:53], v203 offset:3072
    ds_read_b64_tr_b16 v[54:55], v203 offset:3200
    ds_read_b128 v[56:59], v201 offset:16384
    ds_read_b64_tr_b16 v[60:61], v203 offset:4096
    ds_read_b64_tr_b16 v[62:63], v203 offset:4224
    s_waitcnt lgkmcnt(12)
    v_mfma_f32_16x16x32_bf16 v[208:211], v[24:27], v[28:31], 0
    ds_read_b128 v[64:67], v202 offset:16384
    ds_read_b64_tr_b16 v[68:69], v203 offset:5120
    ds_read_b64_tr_b16 v[70:71], v203 offset:5248
    s_waitcnt lgkmcnt(12)
    v_mfma_f32_16x16x32_bf16 v[208:211], v[32:35], v[36:39], v[208:211]
    ds_read_b128 v[24:27], v201 offset:24576
    ds_read_b64_tr_b16 v[28:29], v203 offset:6144
    ds_read_b64_tr_b16 v[30:31], v203 offset:6272
    s_waitcnt lgkmcnt(12)
    v_mfma_f32_16x16x32_bf16 v[208:211], v[40:43], v[44:47], v[208:211]
    ds_read_b128 v[32:35], v202 offset:24576
    ds_read_b64_tr_b16 v[36:37], v203 offset:7168
    ds_read_b64_tr_b16 v[38:39], v203 offset:7296
    s_waitcnt lgkmcnt(12)
    v_mfma_f32_16x16x32_bf16 v[208:211], v[48:51], v[52:55], v[208:211]
    ds_read_b128 v[40:43], v201 offset:32768
    ds_read_b64_tr_b16 v[44:45], v203 offset:8192
    ds_read_b64_tr_b16 v[46:47], v203 offset:8320
    s_waitcnt lgkmcnt(12)
    v_mfma_f32_16x16x32_bf16 v[208:211], v[56:59], v[60:63], v[208:211]
    ds_read_b128 v[48:51], v202 offset:32768
    ds_read_b64_tr_b16 v[52:53], v203 offset:9216
    ds_read_b64_tr_b16 v[54:55], v203 offset:9344
    s_waitcnt lgkmcnt(12)
    v_mfma_f32_16x16x32_bf16 v[208:211], v[64:67], v[68:71], v[208:211]
    ds_read_b128 v[56:59], v201 offset:40960
    ds_read_b64_tr_b16 v[60:61], v203 offset:10240
    ds_read_b64_tr_b16 v[62:63], v203 offset:10368
    s_waitcnt lgkmcnt(12)
    v_mfma_f32_16x16x32_bf16 v[208:211], v[24:27], v[28:31], v[208:211]
    ds_read_b128 v[64:67], v202 offset:40960
    ds_read_b64_tr_b16 v[68:69], v203 offset:11264
    ds_read_b64_tr_b16 v[70:71], v203 offset:11392
    s_waitcnt lgkmcnt(12)
    v_mfma_f32_16x16x32_bf16 v[208:211], v[32:35], v[36:39], v[208:211]
    ds_read_b128 v[24:27], v201 offset:49152
    ds_read_b64_tr_b16 v[28:29], v203 offset:12288
    ds_read_b64_tr_b16 v[30:31], v203 offset:12416
    s_waitcnt lgkmcnt(12)
    v_mfma_f32_16x16x32_bf16 v[208:211], v[40:43], v[44:47], v[208:211]
    ds_read_b128 v[32:35], v202 offset:49152
    ds_read_b64_tr_b16 v[36:37], v203 offset:13312
    ds_read_b64_tr_b16 v[38:39], v203 offset:13440
    s_waitcnt lgkmcnt(12)
    v_mfma_f32_16x16x32_bf16 v[208:211], v[48:51], v[52:55], v[208:211]
    ds_read_b128 v[40:43], v201 offset:57344
    ds_read_b64_tr_b16 v[44:45], v203 offset:14336
    ds_read_b64_tr_b16 v[46:47], v203 offset:14464
    s_waitcnt lgkmcnt(12)
    v_mfma_f32_16x16x32_bf16 v[208:211], v[56:59], v[60:63], v[208:211]
    ds_read_b128 v[48:51], v202 offset:57344
    ds_read_b64_tr_b16 v[52:53], v203 offset:15360
    ds_read_b64_tr_b16 v[54:55], v203 offset:15488
    s_waitcnt lgkmcnt(12)
    v_mfma_f32_16x16x32_bf16 v[208:211], v[64:67], v[68:71], v[208:211]
    s_waitcnt lgkmcnt(9)
    v_mfma_f32_16x16x32_bf16 v[208:211], v[24:27], v[28:31], v[208:211]
    s_waitcnt lgkmcnt(6)
    v_mfma_f32_16x16x32_bf16 v[208:211], v[32:35], v[36:39], v[208:211]
    s_waitcnt lgkmcnt(3)
    v_mfma_f32_16x16x32_bf16 v[208:211], v[40:43], v[44:47], v[208:211]
    s_waitcnt lgkmcnt(0)
    v_mfma_f32_16x16x32_bf16 v[208:211], v[48:51], v[52:55], v[208:211]
    s_mul_i32 s6, s53, 4352
    s_mul_i32 s43, s55, 576
    s_add_u32 s6, s6, s43
    v_lshrrev_b32 v5, 5, v1
    v_mul_u32_u24 v5, 288, v5
    v_lshl_add_u32 v5, v205, 4, v5
    v_and_b32 v6, 1, v206
    v_lshl_add_u32 v5, v6, 3, v5
    s_nop 0
    v_cvt_pk_bf16_f32 v216, v208, v209
    v_cvt_pk_bf16_f32 v217, v210, v211
    buffer_store_dwordx2 v[216:217], v5, s[28:31], s6 offen offset:2048 sc1
    v_mul_u32_u24 v6, 288, v1
    v_mov_b32 v212, 0x3f803f80
    v_mov_b32 v213, 0x3f803f80
    v_mov_b32 v214, 0x3f803f80
    v_mov_b32 v215, 0x3f803f80
    s_mov_b64 exec, 3
    buffer_store_dwordx4 v[212:215], v6, s[28:31], s6 offen offset:2304 sc1
    s_mov_b64 exec, -1
F_kvjoin:
    s_mov_b32 s8, s78
    s_mov_b32 s9, s79
    s_mov_b32 s10, 256
    s_mov_b32 s11, 0x20000
    v_mov_b32 v6, 0
    buffer_load_dword v5, v6, s[8:11], 0 offen sc1
    s_add_u32 s28, s80, 4423680
    s_addc_u32 s29, s81, 0
    s_mov_b32 s30, 139264
    s_mov_b32 s31, 0x20000
    s_lshl_b32 s40, s53, 5
    s_add_u32 s40, s40, s5
    s_lshl_b32 s40, s40, 2
    s_waitcnt vmcnt(0)
    v_readfirstlane_b32 s54, v5
    s_cmp_lg_u32 s54, 0
    s_cbranch_scc1 F_nok
    s_mov_b32 s8, s78
    s_mov_b32 s9, s79
    s_mov_b32 s10, 256
    s_mov_b32 s11, 0x20000
    v_mov_b32 v6, 0
    s_mov_b32 s52, 200000
NON_3:
    buffer_load_dword v5, v6, s[8:11], 0 offen sc1
    s_waitcnt vmcnt(0)
    v_readfirstlane_b32 s54, v5
    s_cmp_lg_u32 s54, 0
    s_cbranch_scc1 NONd_4
    s_sleep 4
    s_sub_u32 s52, s52, 1
    s_cmp_lg_u32 s52, 0
    s_cbranch_scc1 NON_3
NONd_4:
F_nok:
    s_mov_b64 exec, 1
    buffer_store_dword v5, v6, s[28:31], s40 offen sc1
    s_mov_b64 exec, -1
    ds_write_b32 v20, v5 offset:8
F_join:
    v_mov_b64 v[140:141], 0
    v_mov_b64 v[142:143], 0
    v_mov_b64 v[144:145], 0
    v_mov_b64 v[146:147], 0
    v_mov_b64 v[148:149], 0
    v_mov_b64 v[150:151], 0
    v_mov_b64 v[152:153], 0
    v_mov_b64 v[154:155], 0
    v_mov_b64 v[156:157], 0
    v_mov_b64 v[158:159], 0
    s_nop 1
    v_mfma_f32_32x32x16_bf16 v[24:39], v[140:143], v[140:143], 0
    v_mfma_f32_32x32x16_bf16 v[40:55], v[140:143], v[140:143], 0
    v_mfma_f32_32x32x16_bf16 v[56:71], v[140:143], v[140:143], 0
    v_mfma_f32_32x32x16_bf16 v[72:87], v[140:143], v[140:143], 0
    v_mfma_f32_32x32x16_bf16 v[88:103], v[140:143], v[140:143], 0
    v_mfma_f32_32x32x16_bf16 v[104:119], v[140:143], v[140:143], 0
    s_mov_b64 exec, 1
    ds_add_u32 v20, v21 offset:64
    s_mov_b64 exec, -1
    s_and_b32 s61, s3, 1
    s_lshr_b32 s56, s3, 1
    s_and_b32 s6, s5, 1
    s_lshl_b32 s6, s6, 1
    s_xor_b32 s56, s56, s6
    v_bfe_u32 v2, v1, 2, 2
    v_lshrrev_b32 v3, 5, v1
    v_lshl_add_u32 v3, v3, 2, v2
    v_lshlrev_b32 v3, 7, v3
    v_bfe_u32 v2, v1, 3, 1
    v_lshl_add_u32 v3, v2, 6, v3
    v_bfe_u32 v2, v1, 4, 1
    v_lshl_add_u32 v3, v2, 5, v3
    v_and_b32 v2, 3, v1
    v_lshl_add_u32 v233, v2, 3, v3
    s_lshl_b32 s6, s56, 14
    s_add_u32 s6, s6, 65536
    v_add_u32 v232, s6, v233
    v_lshrrev_b32 v3, 1, v1
    v_and_b32 v2, 1, v1
    v_lshlrev_b32 v2, 3, v2
    v_lshl_add_u32 v241, v3, 7, v2
    s_lshl_b32 s6, s4, 2
    s_add_u32 s6, s6, s56
    s_lshl_b32 s6, s6, 6
    s_add_u32 s6, s6, s61
    s_lshl_b32 s6, s6, 2
    s_add_u32 s60, s6, 0x2000
    v_lshlrev_b32 v242, 4, v1
    s_lshl_b32 s6, s4, 1
    s_add_u32 s6, s6, s61
    s_lshl_b32 s59, s6, 15
    s_lshl_b32 s6, s56, 13
    s_add_u32 s57, s59, s6
    s_add_u32 s58, s57, 4096
    v_lshrrev_b32 v2, 3, v1
    v_and_b32 v3, 7, v1
    v_lshlrev_b32 v239, 10, v2
    v_lshl_add_u32 v239, v3, 4, v239
    v_lshlrev_b32 v3, 1, v3
    v_xor_b32 v3, v3, v2
    v_lshlrev_b32 v3, 4, v3
    v_lshl_add_u32 v3, v2, 8, v3
    s_lshl_b32 s6, s3, 11
    v_add_u32 v238, s6, v3
    s_lshl_b32 s6, s4, 3
    s_add_u32 s6, s6, s3
    s_lshl_b32 s59, s6, 13
    s_lshl_b32 s6, s5, 7
    s_add_u32 s59, s59, s6
    s_lshl_b32 s6, s3, 13
    s_add_u32 s6, s6, 65536
    v_and_b32 v2, 7, v1
    v_lshrrev_b32 v3, 5, v1
    v_xor_b32 v3, v3, v2
    v_and_b32 v2, 31, v1
    v_lshlrev_b32 v3, 4, v3
    v_lshl_add_u32 v3, v2, 8, v3
    v_add_u32 v234, s6, v3
    v_xor_b32 v235, 32, v234
    v_xor_b32 v236, 64, v234
    v_xor_b32 v237, 96, v234
    s_lshl_b32 s6, s61, 7
    s_add_u32 s6, s6, 160384
    v_lshl_add_u32 v240, v2, 2, s6
    s_lshl_b32 s63, s33, 14
    v_add_u32 v244, s63, v233
    v_xor_b32 v245, 64, v244
    v_xor_b32 v233, 64, v232
    s_lshl_b32 s6, s33, 16
    s_lshl_b32 s62, s4, 11
    s_add_u32 s6, s6, s62
    v_add_u32 v243, s6, v242
    v_lshlrev_b32 v246, 2, v2
    v_add_u32 v247, s63, v23
    v_lshlrev_b32 v249, 2, v1
    v_mov_b32 v250, 0xc0135761
    v_mov_b32 v251, 0xc0135761
    v_mov_b32 v252, 0xbdd2d3e8
    v_mov_b32 v253, 0xbdd2d3e8
    v_mov_b32 v254, 1.0
    v_mov_b32 v255, 1.0
    s_cmp_eq_u32 s33, 1
    s_cselect_b32 s8, s70, s68
    s_cselect_b32 s9, s71, s69
    s_cmp_eq_u32 s33, 2
    s_cselect_b32 s8, s72, s8
    s_cselect_b32 s9, s73, s9
    s_cmp_eq_u32 s33, 3
    s_cselect_b32 s8, s64, s8
    s_cselect_b32 s9, s65, s9
    s_cselect_b32 s41, 16, 43
    s_mul_i32 s40, s2, s41
    s_lshl_b32 s40, s40, 7
    s_lshl_b32 s41, s41, 7
    s_add_u32 s10, s40, s41
    s_cmp_lt_u32 s33, 2
    s_cselect_b32 s10, 0, s10
    s_mov_b32 s11, 0x20000
    v_lshlrev_b32 v2, 7, v1
LW_5:
    ds_read_b32 v22, v20 offset:64
    s_waitcnt lgkmcnt(0)
    v_readfirstlane_b32 s6, v22
    s_cmp_ge_u32 s6, 4
    s_cbranch_scc1 LWd_6
    s_sleep 1
    s_sub_u32 s98, s98, 1
    s_cbranch_scc0 LW_5
LWd_6:
    s_add_u32 m0, s34, 0
    s_nop 0
    buffer_load_dwordx4 v8, s[12:15], s47 offen lds
    s_add_u32 m0, s35, 0
    s_nop 0
    buffer_load_dwordx4 v9, s[12:15], s47 offen lds
    s_add_u32 m0, s36, 0
    s_nop 0
    buffer_load_dwordx4 v10, s[20:23], s47 offen lds
    s_add_u32 m0, s37, 0
    s_nop 0
    buffer_load_dwordx4 v11, s[16:19], s47 offen lds
    s_add_u32 m0, s38, 0
    s_nop 0
    buffer_load_dwordx4 v12, s[16:19], s47 offen lds
    s_add_u32 m0, s39, 0
    s_nop 0
    buffer_load_dwordx4 v13, s[24:27], s47 offen lds
    s_add_u32 s47, s47, 88064
LW_7:
    ds_read_b32 v22, v20 offset:88
    s_waitcnt lgkmcnt(0)
    v_readfirstlane_b32 s6, v22
    s_cmp_ge_u32 s6, 4
    s_cbranch_scc1 LWd_8
    s_sleep 1
    s_sub_u32 s98, s98, 1
    s_cbranch_scc0 LW_7
LWd_8:
    buffer_load_dword v3, v2, s[8:11], s40 offen
    s_add_u32 m0, s34, 22656
    s_nop 0
    buffer_load_dwordx4 v8, s[12:15], s47 offen lds
    s_add_u32 m0, s35, 22656
    s_nop 0
    buffer_load_dwordx4 v9, s[12:15], s47 offen lds
    s_add_u32 m0, s36, 22656
    s_nop 0
    buffer_load_dwordx4 v10, s[20:23], s47 offen lds
    s_add_u32 m0, s37, 22656
    s_nop 0
    buffer_load_dwordx4 v11, s[16:19], s47 offen lds
    s_add_u32 m0, s38, 22656
    s_nop 0
    buffer_load_dwordx4 v12, s[16:19], s47 offen lds
    s_add_u32 m0, s39, 22656
    s_nop 0
    buffer_load_dwordx4 v13, s[24:27], s47 offen lds
    s_add_u32 s47, s47, 88064
    s_lshr_b32 s6, s2, 3
    s_cmp_eq_u32 s33, 1
    s_cselect_b32 s8, s64, s72
    s_cselect_b32 s9, s65, s73
    s_cselect_b32 s41, 16, 43
    s_mul_i32 s40, s6, s41
    s_lshl_b32 s40, s40, 10
    s_lshl_b32 s41, s41, 10
    s_add_u32 s10, s40, s41
    s_cmp_ge_u32 s33, 2
    s_cselect_b32 s10, 0, s10
    s_and_b32 s6, s2, 0
    s_cmp_lg_u32 s6, 0
    s_cselect_b32 s10, 0, s10
    v_lshlrev_b32 v4, 10, v1
    s_mov_b32 s11, 0x20000
    s_lshl_b32 s6, s33, 13
    v_add_u32 v7, s6, v23
    v_lshlrev_b32 v5, 2, v1
    v_add_u32 v5, 160384, v5
    v_cmp_eq_u32 vcc, 0, v1
    s_nop 1
    v_cndmask_b32 v5, v5, v20, vcc
    s_setprio 2
    s_waitcnt vmcnt(7)
    s_mov_b64 exec, 1
    ds_add_u32 v20, v21 offset:0
    s_mov_b64 exec, -1
    s_mov_b32 s50, 4
    s_mov_b32 s51, 3
LW_9:
    ds_read_b32 v22, v20 offset:0
    s_waitcnt lgkmcnt(0)
    v_readfirstlane_b32 s6, v22
    s_cmp_ge_u32 s6, s50
    s_cbranch_scc1 LWd_10
    s_sleep 1
    s_sub_u32 s98, s98, 1
    s_cbranch_scc0 LW_9
LWd_10:
    s_cmp_eq_u32 s33, 3
    s_cbranch_scc1 G1L_start
    s_mul_i32 s6, s5, 11
    s_add_u32 s6, s6, s33
    s_cmp_ge_u32 s6, 78
    s_cbranch_scc1 G1L_start
    s_setprio 0
    ds_read_b128 v[120:123], v14 offset:0
    ds_read_b128 v[124:127], v14 offset:4096
    ds_read_b64_tr_b16 v[128:129], v18 offset:0
    ds_read_b64_tr_b16 v[130:131], v18 offset:1408
    ds_read_b64_tr_b16 v[132:133], v18 offset:128
    ds_read_b64_tr_b16 v[134:135], v18 offset:1536
    ds_read_b64_tr_b16 v[136:137], v18 offset:256
    ds_read_b64_tr_b16 v[138:139], v18 offset:1664
    s_add_u32 m0, s34, 45312
    s_nop 0
    buffer_load_dwordx4 v8, s[12:15], s47 offen lds
    s_add_u32 m0, s35, 45312
    s_nop 0
    buffer_load_dwordx4 v9, s[12:15], s47 offen lds
    s_add_u32 m0, s36, 45312
    s_nop 0
    buffer_load_dwordx4 v10, s[20:23], s47 offen lds
    s_add_u32 m0, s37, 45312
    s_nop 0
    buffer_load_dwordx4 v11, s[16:19], s47 offen lds
    s_add_u32 m0, s38, 45312
    s_nop 0
    buffer_load_dwordx4 v12, s[16:19], s47 offen lds
    s_add_u32 m0, s39, 45312
    s_nop 0
    buffer_load_dwordx4 v13, s[24:27], s47 offen lds
    s_add_u32 s47, s47, 88064
    ds_read_b128 v[140:143], v15 offset:0
    ds_read_b128 v[144:147], v15 offset:4096
    ds_read_b64_tr_b16 v[148:149], v18 offset:5632
    ds_read_b64_tr_b16 v[150:151], v18 offset:7040
    ds_read_b64_tr_b16 v[152:153], v18 offset:5760
    ds_read_b64_tr_b16 v[154:155], v18 offset:7168
    ds_read_b64_tr_b16 v[156:157], v18 offset:5888
    ds_read_b64_tr_b16 v[158:159], v18 offset:7296
    s_waitcnt vmcnt(6)
    ds_add_u32 v5, v21
    s_add_u32 s50, s50, 4
    s_waitcnt lgkmcnt(9)
    s_add_u32 m0, s34, 67968
    v_mfma_f32_32x32x16_bf16 v[24:39], v[128:131], v[120:123], v[24:39]
    buffer_load_dwordx4 v8, s[12:15], s47 offen lds
    s_add_u32 m0, s35, 67968
    v_mfma_f32_32x32x16_bf16 v[40:55], v[128:131], v[124:127], v[40:55]
    buffer_load_dwordx4 v9, s[12:15], s47 offen lds
    s_add_u32 m0, s36, 67968
    v_mfma_f32_32x32x16_bf16 v[56:71], v[132:135], v[120:123], v[56:71]
    buffer_load_dwordx4 v10, s[20:23], s47 offen lds
    s_add_u32 m0, s37, 67968
    v_mfma_f32_32x32x16_bf16 v[72:87], v[132:135], v[124:127], v[72:87]
    buffer_load_dwordx4 v11, s[16:19], s47 offen lds
    s_add_u32 m0, s38, 67968
    v_mfma_f32_32x32x16_bf16 v[88:103], v[136:139], v[120:123], v[88:103]
    buffer_load_dwordx4 v12, s[16:19], s47 offen lds
    s_add_u32 m0, s39, 67968
    v_mfma_f32_32x32x16_bf16 v[104:119], v[136:139], v[124:127], v[104:119]
    buffer_load_dwordx4 v13, s[24:27], s47 offen lds
    s_add_u32 s47, s47, 88064
    s_setprio 2
LW_11:
    ds_read_b32 v22, v20 offset:0
    s_waitcnt lgkmcnt(0)
    v_readfirstlane_b32 s6, v22
    s_cmp_ge_u32 s6, s50
    s_cbranch_scc1 LWd_12
    s_sleep 1
    s_sub_u32 s98, s98, 1
    s_cbranch_scc0 LW_11
LWd_12:
    s_setprio 0
    s_branch G1_mid
.p2align 6
G1_loop:
    ds_read_b128 v[120:123], v14 offset:0
    ds_read_b128 v[124:127], v14 offset:4096
    ds_read_b64_tr_b16 v[128:129], v18 offset:0
    ds_read_b64_tr_b16 v[130:131], v18 offset:1408
    ds_read_b64_tr_b16 v[132:133], v18 offset:128
    ds_read_b64_tr_b16 v[134:135], v18 offset:1536
    ds_read_b64_tr_b16 v[136:137], v18 offset:256
    ds_read_b64_tr_b16 v[138:139], v18 offset:1664
    s_add_u32 m0, s34, 67968
    v_mfma_f32_32x32x16_bf16 v[24:39], v[148:151], v[140:143], v[24:39]
    buffer_load_dwordx4 v8, s[12:15], s47 offen lds
    v_mfma_f32_32x32x16_bf16 v[40:55], v[148:151], v[144:147], v[40:55]
    s_add_u32 m0, s35, 67968
    v_mfma_f32_32x32x16_bf16 v[56:71], v[152:155], v[140:143], v[56:71]
    buffer_load_dwordx4 v9, s[12:15], s47 offen lds
    v_mfma_f32_32x32x16_bf16 v[72:87], v[152:155], v[144:147], v[72:87]
    s_add_u32 m0, s36, 67968
    v_mfma_f32_32x32x16_bf16 v[88:103], v[156:159], v[140:143], v[88:103]
    buffer_load_dwordx4 v10, s[20:23], s47 offen lds
    v_mfma_f32_32x32x16_bf16 v[104:119], v[156:159], v[144:147], v[104:119]
    ds_read_b128 v[140:143], v15 offset:0
    ds_read_b128 v[144:147], v15 offset:4096
    ds_read_b64_tr_b16 v[148:149], v18 offset:5632
    ds_read_b64_tr_b16 v[150:151], v18 offset:7040
    ds_read_b64_tr_b16 v[152:153], v18 offset:5760
    ds_read_b64_tr_b16 v[154:155], v18 offset:7168
    ds_read_b64_tr_b16 v[156:157], v18 offset:5888
    ds_read_b64_tr_b16 v[158:159], v18 offset:7296
    s_waitcnt vmcnt(9)
    ds_add_u32 v5, v21
    s_add_u32 s50, s50, 4
    s_waitcnt lgkmcnt(9)
    s_add_u32 m0, s37, 67968
    v_mfma_f32_32x32x16_bf16 v[24:39], v[128:131], v[120:123], v[24:39]
    buffer_load_dwordx4 v11, s[16:19], s47 offen lds
    v_mfma_f32_32x32x16_bf16 v[40:55], v[128:131], v[124:127], v[40:55]
    s_add_u32 m0, s38, 67968
    v_mfma_f32_32x32x16_bf16 v[56:71], v[132:135], v[120:123], v[56:71]
    buffer_load_dwordx4 v12, s[16:19], s47 offen lds
    v_mfma_f32_32x32x16_bf16 v[72:87], v[132:135], v[124:127], v[72:87]
    s_add_u32 m0, s39, 67968
    v_mfma_f32_32x32x16_bf16 v[88:103], v[136:139], v[120:123], v[88:103]
    buffer_load_dwordx4 v13, s[24:27], s47 offen lds
    ds_read_b32 v22, v20 offset:0
    v_mfma_f32_32x32x16_bf16 v[104:119], v[136:139], v[124:127], v[104:119]
    s_add_u32 s47, s47, 88064
    s_setprio 2
    s_waitcnt lgkmcnt(0)
    v_readfirstlane_b32 s6, v22
    s_setprio 0
    s_cmp_ge_u32 s6, s50
    s_cbranch_scc1 G1_ok_13
LW_14:
    ds_read_b32 v22, v20 offset:0
    s_waitcnt lgkmcnt(0)
    v_readfirstlane_b32 s6, v22
    s_cmp_ge_u32 s6, s50
    s_cbranch_scc1 LWd_15
    s_sleep 1
    s_sub_u32 s98, s98, 1
    s_cbranch_scc0 LW_14
LWd_15:
G1_ok_13:
G1_mid:
    ds_read_b128 v[120:123], v16 offset:0
    ds_read_b128 v[124:127], v16 offset:4096
    ds_read_b64_tr_b16 v[128:129], v18 offset:22656
    ds_read_b64_tr_b16 v[130:131], v18 offset:24064
    ds_read_b64_tr_b16 v[132:133], v18 offset:22784
    ds_read_b64_tr_b16 v[134:135], v18 offset:24192
    ds_read_b64_tr_b16 v[136:137], v18 offset:22912
    ds_read_b64_tr_b16 v[138:139], v18 offset:24320
    s_add_u32 m0, s34, 0
    v_mfma_f32_32x32x16_bf16 v[24:39], v[148:151], v[140:143], v[24:39]
    buffer_load_dwordx4 v8, s[12:15], s47 offen lds
    v_mfma_f32_32x32x16_bf16 v[40:55], v[148:151], v[144:147], v[40:55]
    s_add_u32 m0, s35, 0
    v_mfma_f32_32x32x16_bf16 v[56:71], v[152:155], v[140:143], v[56:71]
    buffer_load_dwordx4 v9, s[12:15], s47 offen lds
    v_mfma_f32_32x32x16_bf16 v[72:87], v[152:155], v[144:147], v[72:87]
    s_add_u32 m0, s36, 0
    v_mfma_f32_32x32x16_bf16 v[88:103], v[156:159], v[140:143], v[88:103]
    buffer_load_dwordx4 v10, s[20:23], s47 offen lds
    v_mfma_f32_32x32x16_bf16 v[104:119], v[156:159], v[144:147], v[104:119]
    ds_read_b128 v[140:143], v17 offset:0
    ds_read_b128 v[144:147], v17 offset:4096
    ds_read_b64_tr_b16 v[148:149], v18 offset:28288
    ds_read_b64_tr_b16 v[150:151], v18 offset:29696
    ds_read_b64_tr_b16 v[152:153], v18 offset:28416
    ds_read_b64_tr_b16 v[154:155], v18 offset:29824
    ds_read_b64_tr_b16 v[156:157], v18 offset:28544
    ds_read_b64_tr_b16 v[158:159], v18 offset:29952
    s_waitcnt vmcnt(9)
    ds_add_u32 v5, v21
    s_add_u32 s50, s50, 4
    s_waitcnt lgkmcnt(9)
    s_add_u32 m0, s37, 0
    v_mfma_f32_32x32x16_bf16 v[24:39], v[128:131], v[120:123], v[24:39]
    buffer_load_dwordx4 v11, s[16:19], s47 offen lds
    v_mfma_f32_32x32x16_bf16 v[40:55], v[128:131], v[124:127], v[40:55]
    s_add_u32 m0, s38, 0
    v_mfma_f32_32x32x16_bf16 v[56:71], v[132:135], v[120:123], v[56:71]
    buffer_load_dwordx4 v12, s[16:19], s47 offen lds
    v_mfma_f32_32x32x16_bf16 v[72:87], v[132:135], v[124:127], v[72:87]
    s_add_u32 m0, s39, 0
    v_mfma_f32_32x32x16_bf16 v[88:103], v[136:139], v[120:123], v[88:103]
    buffer_load_dwordx4 v13, s[24:27], s47 offen lds
    ds_read_b32 v22, v20 offset:0
    v_mfma_f32_32x32x16_bf16 v[104:119], v[136:139], v[124:127], v[104:119]
    s_add_u32 s47, s47, 88064
    s_setprio 2
    s_waitcnt lgkmcnt(0)
    v_readfirstlane_b32 s6, v22
    s_setprio 0
    s_cmp_ge_u32 s6, s50
    s_cbranch_scc1 G1_ok_16
LW_17:
    ds_read_b32 v22, v20 offset:0
    s_waitcnt lgkmcnt(0)
    v_readfirstlane_b32 s6, v22
    s_cmp_ge_u32 s6, s50
    s_cbranch_scc1 LWd_18
    s_sleep 1
    s_sub_u32 s98, s98, 1
    s_cbranch_scc0 LW_17
LWd_18:
G1_ok_16:
    ds_read_b128 v[120:123], v14 offset:8192
    ds_read_b128 v[124:127], v14 offset:12288
    ds_read_b64_tr_b16 v[128:129], v19 offset:0
    ds_read_b64_tr_b16 v[130:131], v19 offset:1408
    ds_read_b64_tr_b16 v[132:133], v19 offset:128
    ds_read_b64_tr_b16 v[134:135], v19 offset:1536
    ds_read_b64_tr_b16 v[136:137], v19 offset:256
    ds_read_b64_tr_b16 v[138:139], v19 offset:1664
    s_add_u32 m0, s34, 22656
    v_mfma_f32_32x32x16_bf16 v[24:39], v[148:151], v[140:143], v[24:39]
    buffer_load_dwordx4 v8, s[12:15], s47 offen lds
    v_mfma_f32_32x32x16_bf16 v[40:55], v[148:151], v[144:147], v[40:55]
    s_add_u32 m0, s35, 22656
    v_mfma_f32_32x32x16_bf16 v[56:71], v[152:155], v[140:143], v[56:71]
    buffer_load_dwordx4 v9, s[12:15], s47 offen lds
    v_mfma_f32_32x32x16_bf16 v[72:87], v[152:155], v[144:147], v[72:87]
    s_add_u32 m0, s36, 22656
    v_mfma_f32_32x32x16_bf16 v[88:103], v[156:159], v[140:143], v[88:103]
    buffer_load_dwordx4 v10, s[20:23], s47 offen lds
    v_mfma_f32_32x32x16_bf16 v[104:119], v[156:159], v[144:147], v[104:119]
    ds_read_b128 v[140:143], v15 offset:8192
    ds_read_b128 v[144:147], v15 offset:12288
    ds_read_b64_tr_b16 v[148:149], v19 offset:5632
    ds_read_b64_tr_b16 v[150:151], v19 offset:7040
    ds_read_b64_tr_b16 v[152:153], v19 offset:5760
    ds_read_b64_tr_b16 v[154:155], v19 offset:7168
    ds_read_b64_tr_b16 v[156:157], v19 offset:5888
    ds_read_b64_tr_b16 v[158:159], v19 offset:7296
    s_waitcnt vmcnt(9)
    ds_add_u32 v5, v21
    s_add_u32 s50, s50, 4
    s_waitcnt lgkmcnt(9)
    s_add_u32 m0, s37, 22656
    v_mfma_f32_32x32x16_bf16 v[24:39], v[128:131], v[120:123], v[24:39]
    buffer_load_dwordx4 v11, s[16:19], s47 offen lds
    v_mfma_f32_32x32x16_bf16 v[40:55], v[128:131], v[124:127], v[40:55]
    s_add_u32 m0, s38, 22656
    v_mfma_f32_32x32x16_bf16 v[56:71], v[132:135], v[120:123], v[56:71]
    buffer_load_dwordx4 v12, s[16:19], s47 offen lds
    v_mfma_f32_32x32x16_bf16 v[72:87], v[132:135], v[124:127], v[72:87]
    s_add_u32 m0, s39, 22656
    v_mfma_f32_32x32x16_bf16 v[88:103], v[136:139], v[120:123], v[88:103]
    buffer_load_dwordx4 v13, s[24:27], s47 offen lds
    ds_read_b32 v22, v20 offset:0
    v_mfma_f32_32x32x16_bf16 v[104:119], v[136:139], v[124:127], v[104:119]
    s_add_u32 s47, s47, 88064
    s_setprio 2
    s_waitcnt lgkmcnt(0)
    v_readfirstlane_b32 s6, v22
    s_setprio 0
    s_cmp_ge_u32 s6, s50
    s_cbranch_scc1 G1_ok_19
LW_20:
    ds_read_b32 v22, v20 offset:0
    s_waitcnt lgkmcnt(0)
    v_readfirstlane_b32 s6, v22
    s_cmp_ge_u32 s6, s50
    s_cbranch_scc1 LWd_21
    s_sleep 1
    s_sub_u32 s98, s98, 1
    s_cbranch_scc0 LW_20
LWd_21:
G1_ok_19:
    ds_read_b128 v[120:123], v16 offset:8192
    ds_read_b128 v[124:127], v16 offset:12288
    ds_read_b64_tr_b16 v[128:129], v19 offset:22656
    ds_read_b64_tr_b16 v[130:131], v19 offset:24064
    ds_read_b64_tr_b16 v[132:133], v19 offset:22784
    ds_read_b64_tr_b16 v[134:135], v19 offset:24192
    ds_read_b64_tr_b16 v[136:137], v19 offset:22912
    ds_read_b64_tr_b16 v[138:139], v19 offset:24320
    s_add_u32 m0, s34, 45312
    v_mfma_f32_32x32x16_bf16 v[24:39], v[148:151], v[140:143], v[24:39]
    buffer_load_dwordx4 v8, s[12:15], s47 offen lds
    v_mfma_f32_32x32x16_bf16 v[40:55], v[148:151], v[144:147], v[40:55]
    s_add_u32 m0, s35, 45312
    v_mfma_f32_32x32x16_bf16 v[56:71], v[152:155], v[140:143], v[56:71]
    buffer_load_dwordx4 v9, s[12:15], s47 offen lds
    v_mfma_f32_32x32x16_bf16 v[72:87], v[152:155], v[144:147], v[72:87]
    s_add_u32 m0, s36, 45312
    v_mfma_f32_32x32x16_bf16 v[88:103], v[156:159], v[140:143], v[88:103]
    buffer_load_dwordx4 v10, s[20:23], s47 offen lds
    v_mfma_f32_32x32x16_bf16 v[104:119], v[156:159], v[144:147], v[104:119]
    ds_read_b128 v[140:143], v17 offset:8192
    ds_read_b128 v[144:147], v17 offset:12288
    ds_read_b64_tr_b16 v[148:149], v19 offset:28288
    ds_read_b64_tr_b16 v[150:151], v19 offset:29696
    ds_read_b64_tr_b16 v[152:153], v19 offset:28416
    ds_read_b64_tr_b16 v[154:155], v19 offset:29824
    ds_read_b64_tr_b16 v[156:157], v19 offset:28544
    ds_read_b64_tr_b16 v[158:159], v19 offset:29952
    s_waitcnt vmcnt(9)
    ds_add_u32 v5, v21
    s_add_u32 s50, s50, 4
    s_waitcnt lgkmcnt(9)
    s_add_u32 m0, s37, 45312
    v_mfma_f32_32x32x16_bf16 v[24:39], v[128:131], v[120:123], v[24:39]
    buffer_load_dwordx4 v11, s[16:19], s47 offen lds
    v_mfma_f32_32x32x16_bf16 v[40:55], v[128:131], v[124:127], v[40:55]
    s_add_u32 m0, s38, 45312
    v_mfma_f32_32x32x16_bf16 v[56:71], v[132:135], v[120:123], v[56:71]
    buffer_load_dwordx4 v12, s[16:19], s47 offen lds
    v_mfma_f32_32x32x16_bf16 v[72:87], v[132:135], v[124:127], v[72:87]
    s_add_u32 m0, s39, 45312
    v_mfma_f32_32x32x16_bf16 v[88:103], v[136:139], v[120:123], v[88:103]
    buffer_load_dwordx4 v13, s[24:27], s47 offen lds
    ds_read_b32 v22, v20 offset:0
    v_mfma_f32_32x32x16_bf16 v[104:119], v[136:139], v[124:127], v[104:119]
    s_add_u32 s47, s47, 88064
    s_setprio 2
    s_waitcnt lgkmcnt(0)
    v_readfirstlane_b32 s6, v22
    v_add_u32 v14, 16384, v14
    v_add_u32 v15, 16384, v15
    v_add_u32 v16, 16384, v16
    v_add_u32 v17, 16384, v17
    s_setprio 0
    s_cmp_ge_u32 s6, s50
    s_cbranch_scc1 G1_ok_22
LW_23:
    ds_read_b32 v22, v20 offset:0
    s_waitcnt lgkmcnt(0)
    v_readfirstlane_b32 s6, v22
    s_cmp_ge_u32 s6, s50
    s_cbranch_scc1 LWd_24
    s_sleep 1
    s_sub_u32 s98, s98, 1
    s_cbranch_scc0 LW_23
LWd_24:
G1_ok_22:
    s_sub_u32 s51, s51, 1
    s_cmp_lg_u32 s51, 0
    s_cbranch_scc1 G1_loop
    buffer_load_dword v3, v4, s[8:11], s40 offen offset:384
    ds_read_b128 v[120:123], v14 offset:0
    ds_read_b128 v[124:127], v14 offset:4096
    ds_read_b64_tr_b16 v[128:129], v18 offset:0
    ds_read_b64_tr_b16 v[130:131], v18 offset:1408
    ds_read_b64_tr_b16 v[132:133], v18 offset:128
    ds_read_b64_tr_b16 v[134:135], v18 offset:1536
    ds_read_b64_tr_b16 v[136:137], v18 offset:256
    ds_read_b64_tr_b16 v[138:139], v18 offset:1664
    s_add_u32 m0, s34, 67968
    v_mfma_f32_32x32x16_bf16 v[24:39], v[148:151], v[140:143], v[24:39]
    buffer_load_dwordx4 v8, s[12:15], s47 offen lds
    v_mfma_f32_32x32x16_bf16 v[40:55], v[148:151], v[144:147], v[40:55]
    s_add_u32 m0, s35, 67968
    v_mfma_f32_32x32x16_bf16 v[56:71], v[152:155], v[140:143], v[56:71]
    buffer_load_dwordx4 v9, s[12:15], s47 offen lds
    v_mfma_f32_32x32x16_bf16 v[72:87], v[152:155], v[144:147], v[72:87]
    s_add_u32 m0, s36, 67968
    v_mfma_f32_32x32x16_bf16 v[88:103], v[156:159], v[140:143], v[88:103]
    buffer_load_dwordx4 v10, s[20:23], s47 offen lds
    v_mfma_f32_32x32x16_bf16 v[104:119], v[156:159], v[144:147], v[104:119]
    ds_read_b128 v[140:143], v15 offset:0
    ds_read_b128 v[144:147], v15 offset:4096
    ds_read_b64_tr_b16 v[148:149], v18 offset:5632
    ds_read_b64_tr_b16 v[150:151], v18 offset:7040
    ds_read_b64_tr_b16 v[152:153], v18 offset:5760
    ds_read_b64_tr_b16 v[154:155], v18 offset:7168
    ds_read_b64_tr_b16 v[156:157], v18 offset:5888
    ds_read_b64_tr_b16 v[158:159], v18 offset:7296
    s_waitcnt vmcnt(9)
    ds_add_u32 v5, v21
    s_add_u32 s50, s50, 4
    s_waitcnt lgkmcnt(9)
    s_add_u32 m0, s37, 67968
    v_mfma_f32_32x32x16_bf16 v[24:39], v[128:131], v[120:123], v[24:39]
    buffer_load_dwordx4 v11, s[16:19], s47 offen lds
    v_mfma_f32_32x32x16_bf16 v[40:55], v[128:131], v[124:127], v[40:55]
    s_add_u32 m0, s38, 67968
    v_mfma_f32_32x32x16_bf16 v[56:71], v[132:135], v[120:123], v[56:71]
    buffer_load_dwordx4 v12, s[16:19], s47 offen lds
    v_mfma_f32_32x32x16_bf16 v[72:87], v[132:135], v[124:127], v[72:87]
    s_add_u32 m0, s39, 67968
    v_mfma_f32_32x32x16_bf16 v[88:103], v[136:139], v[120:123], v[88:103]
    buffer_load_dwordx4 v13, s[24:27], s47 offen lds
    ds_read_b32 v22, v20 offset:0
    v_mfma_f32_32x32x16_bf16 v[104:119], v[136:139], v[124:127], v[104:119]
    s_add_u32 s47, s47, 88064
    s_setprio 2
    s_waitcnt lgkmcnt(0)
    v_readfirstlane_b32 s6, v22
    s_setprio 0
    s_cmp_ge_u32 s6, s50
    s_cbranch_scc1 G1_ok_25
LW_26:
    ds_read_b32 v22, v20 offset:0
    s_waitcnt lgkmcnt(0)
    v_readfirstlane_b32 s6, v22
    s_cmp_ge_u32 s6, s50
    s_cbranch_scc1 LWd_27
    s_sleep 1
    s_sub_u32 s98, s98, 1
    s_cbranch_scc0 LW_26
LWd_27:
G1_ok_25:
    s_mov_b32 s8, s64
    s_mov_b32 s9, s65
    s_mov_b32 s10, 524288
    s_mov_b32 s11, 0x20000
    ds_read_b128 v[120:123], v16 offset:0
    ds_read_b128 v[124:127], v16 offset:4096
    ds_read_b64_tr_b16 v[128:129], v18 offset:22656
    ds_read_b64_tr_b16 v[130:131], v18 offset:24064
    ds_read_b64_tr_b16 v[132:133], v18 offset:22784
    ds_read_b64_tr_b16 v[134:135], v18 offset:24192
    ds_read_b64_tr_b16 v[136:137], v18 offset:22912
    ds_read_b64_tr_b16 v[138:139], v18 offset:24320
    s_add_u32 m0, s7, 65536
    s_mov_b32 s6, 0
    v_mfma_f32_32x32x16_bf16 v[24:39], v[148:151], v[140:143], v[24:39]
    buffer_load_dwordx4 v7, s[8:11], s6 offen lds
    v_mfma_f32_32x32x16_bf16 v[40:55], v[148:151], v[144:147], v[40:55]
    s_add_u32 m0, s7, 69632
    s_mov_b32 s6, 32768
    v_mfma_f32_32x32x16_bf16 v[56:71], v[152:155], v[140:143], v[56:71]
    buffer_load_dwordx4 v7, s[8:11], s6 offen lds
    v_mfma_f32_32x32x16_bf16 v[72:87], v[152:155], v[144:147], v[72:87]
    s_add_u32 m0, s7, 73728
    s_mov_b32 s6, 65536
    v_mfma_f32_32x32x16_bf16 v[88:103], v[156:159], v[140:143], v[88:103]
    buffer_load_dwordx4 v7, s[8:11], s6 offen lds
    v_mfma_f32_32x32x16_bf16 v[104:119], v[156:159], v[144:147], v[104:119]
    ds_read_b128 v[140:143], v17 offset:0
    ds_read_b128 v[144:147], v17 offset:4096
    ds_read_b64_tr_b16 v[148:149], v18 offset:28288
    ds_read_b64_tr_b16 v[150:151], v18 offset:29696
    ds_read_b64_tr_b16 v[152:153], v18 offset:28416
    ds_read_b64_tr_b16 v[154:155], v18 offset:29824
    ds_read_b64_tr_b16 v[156:157], v18 offset:28544
    ds_read_b64_tr_b16 v[158:159], v18 offset:29952
    s_waitcnt vmcnt(9)
    ds_add_u32 v5, v21
    s_add_u32 s50, s50, 4
    s_waitcnt lgkmcnt(9)
    s_add_u32 m0, s7, 77824
    s_mov_b32 s6, 98304
    v_mfma_f32_32x32x16_bf16 v[24:39], v[128:131], v[120:123], v[24:39]
    buffer_load_dwordx4 v7, s[8:11], s6 offen lds
    v_mfma_f32_32x32x16_bf16 v[40:55], v[128:131], v[124:127], v[40:55]
    s_add_u32 m0, s7, 81920
    s_mov_b32 s6, 131072
    v_mfma_f32_32x32x16_bf16 v[56:71], v[132:135], v[120:123], v[56:71]
    buffer_load_dwordx4 v7, s[8:11], s6 offen lds
    v_mfma_f32_32x32x16_bf16 v[72:87], v[132:135], v[124:127], v[72:87]
    v_mfma_f32_32x32x16_bf16 v[88:103], v[136:139], v[120:123], v[88:103]
    ds_read_b32 v22, v20 offset:0
    v_mfma_f32_32x32x16_bf16 v[104:119], v[136:139], v[124:127], v[104:119]
    s_add_u32 s47, s47, 88064
    s_setprio 2
    s_waitcnt lgkmcnt(0)
    v_readfirstlane_b32 s6, v22
    s_setprio 0
    s_cmp_ge_u32 s6, s50
    s_cbranch_scc1 G1_ok_28
LW_29:
    ds_read_b32 v22, v20 offset:0
    s_waitcnt lgkmcnt(0)
    v_readfirstlane_b32 s6, v22
    s_cmp_ge_u32 s6, s50
    s_cbranch_scc1 LWd_30
    s_sleep 1
    s_sub_u32 s98, s98, 1
    s_cbranch_scc0 LW_29
LWd_30:
G1_ok_28:
    ds_read_b128 v[120:123], v14 offset:8192
    ds_read_b128 v[124:127], v14 offset:12288
    ds_read_b64_tr_b16 v[128:129], v19 offset:0
    ds_read_b64_tr_b16 v[130:131], v19 offset:1408
    ds_read_b64_tr_b16 v[132:133], v19 offset:128
    ds_read_b64_tr_b16 v[134:135], v19 offset:1536
    ds_read_b64_tr_b16 v[136:137], v19 offset:256
    ds_read_b64_tr_b16 v[138:139], v19 offset:1664
    s_add_u32 m0, s7, 86016
    s_mov_b32 s6, 163840
    v_mfma_f32_32x32x16_bf16 v[24:39], v[148:151], v[140:143], v[24:39]
    buffer_load_dwordx4 v7, s[8:11], s6 offen lds
    v_mfma_f32_32x32x16_bf16 v[40:55], v[148:151], v[144:147], v[40:55]
    s_add_u32 m0, s7, 90112
    s_mov_b32 s6, 196608
    v_mfma_f32_32x32x16_bf16 v[56:71], v[152:155], v[140:143], v[56:71]
    buffer_load_dwordx4 v7, s[8:11], s6 offen lds
    v_mfma_f32_32x32x16_bf16 v[72:87], v[152:155], v[144:147], v[72:87]
    s_add_u32 m0, s7, 94208
    s_mov_b32 s6, 229376
    v_mfma_f32_32x32x16_bf16 v[88:103], v[156:159], v[140:143], v[88:103]
    buffer_load_dwordx4 v7, s[8:11], s6 offen lds
    v_mfma_f32_32x32x16_bf16 v[104:119], v[156:159], v[144:147], v[104:119]
    ds_read_b128 v[140:143], v15 offset:8192
    ds_read_b128 v[144:147], v15 offset:12288
    ds_read_b64_tr_b16 v[148:149], v19 offset:5632
    ds_read_b64_tr_b16 v[150:151], v19 offset:7040
    ds_read_b64_tr_b16 v[152:153], v19 offset:5760
    ds_read_b64_tr_b16 v[154:155], v19 offset:7168
    ds_read_b64_tr_b16 v[156:157], v19 offset:5888
    ds_read_b64_tr_b16 v[158:159], v19 offset:7296
    s_waitcnt vmcnt(8)
    ds_add_u32 v5, v21
    s_add_u32 s50, s50, 4
    s_waitcnt lgkmcnt(9)
    s_add_u32 m0, s7, 98304
    s_mov_b32 s6, 262144
    v_mfma_f32_32x32x16_bf16 v[24:39], v[128:131], v[120:123], v[24:39]
    buffer_load_dwordx4 v7, s[8:11], s6 offen lds
    v_mfma_f32_32x32x16_bf16 v[40:55], v[128:131], v[124:127], v[40:55]
    s_add_u32 m0, s7, 102400
    s_mov_b32 s6, 294912
    v_mfma_f32_32x32x16_bf16 v[56:71], v[132:135], v[120:123], v[56:71]
    buffer_load_dwordx4 v7, s[8:11], s6 offen lds
    v_mfma_f32_32x32x16_bf16 v[72:87], v[132:135], v[124:127], v[72:87]
    s_add_u32 m0, s7, 106496
    s_mov_b32 s6, 327680
    v_mfma_f32_32x32x16_bf16 v[88:103], v[136:139], v[120:123], v[88:103]
    buffer_load_dwordx4 v7, s[8:11], s6 offen lds
    ds_read_b32 v22, v20 offset:0
    v_mfma_f32_32x32x16_bf16 v[104:119], v[136:139], v[124:127], v[104:119]
    s_add_u32 s47, s47, 88064
    s_setprio 2
    s_waitcnt lgkmcnt(0)
    v_readfirstlane_b32 s6, v22
    s_setprio 0
    s_cmp_ge_u32 s6, s50
    s_cbranch_scc1 G1_ok_31
LW_32:
    ds_read_b32 v22, v20 offset:0
    s_waitcnt lgkmcnt(0)
    v_readfirstlane_b32 s6, v22
    s_cmp_ge_u32 s6, s50
    s_cbranch_scc1 LWd_33
    s_sleep 1
    s_sub_u32 s98, s98, 1
    s_cbranch_scc0 LW_32
LWd_33:
G1_ok_31:
    ds_read_b128 v[120:123], v16 offset:8192
    ds_read_b128 v[124:127], v16 offset:12288
    ds_read_b64_tr_b16 v[128:129], v19 offset:22656
    ds_read_b64_tr_b16 v[130:131], v19 offset:24064
    ds_read_b64_tr_b16 v[132:133], v19 offset:22784
    ds_read_b64_tr_b16 v[134:135], v19 offset:24192
    ds_read_b64_tr_b16 v[136:137], v19 offset:22912
    ds_read_b64_tr_b16 v[138:139], v19 offset:24320
    s_add_u32 m0, s7, 110592
    s_mov_b32 s6, 360448
    v_mfma_f32_32x32x16_bf16 v[24:39], v[148:151], v[140:143], v[24:39]
    buffer_load_dwordx4 v7, s[8:11], s6 offen lds
    v_mfma_f32_32x32x16_bf16 v[40:55], v[148:151], v[144:147], v[40:55]
    s_add_u32 m0, s7, 114688
    s_mov_b32 s6, 393216
    v_mfma_f32_32x32x16_bf16 v[56:71], v[152:155], v[140:143], v[56:71]
    buffer_load_dwordx4 v7, s[8:11], s6 offen lds
    v_mfma_f32_32x32x16_bf16 v[72:87], v[152:155], v[144:147], v[72:87]
    s_add_u32 m0, s7, 118784
    s_mov_b32 s6, 425984
    v_mfma_f32_32x32x16_bf16 v[88:103], v[156:159], v[140:143], v[88:103]
    buffer_load_dwordx4 v7, s[8:11], s6 offen lds
    v_mfma_f32_32x32x16_bf16 v[104:119], v[156:159], v[144:147], v[104:119]
    ds_read_b128 v[140:143], v17 offset:8192
    ds_read_b128 v[144:147], v17 offset:12288
    ds_read_b64_tr_b16 v[148:149], v19 offset:28288
    ds_read_b64_tr_b16 v[150:151], v19 offset:29696
    ds_read_b64_tr_b16 v[152:153], v19 offset:28416
    ds_read_b64_tr_b16 v[154:155], v19 offset:29824
    ds_read_b64_tr_b16 v[156:157], v19 offset:28544
    ds_read_b64_tr_b16 v[158:159], v19 offset:29952
    ds_add_u32 v5, v21
    s_add_u32 s50, s50, 4
    s_waitcnt lgkmcnt(9)
    s_add_u32 m0, s7, 122880
    s_mov_b32 s6, 458752
    v_mfma_f32_32x32x16_bf16 v[24:39], v[128:131], v[120:123], v[24:39]
    buffer_load_dwordx4 v7, s[8:11], s6 offen lds
    v_mfma_f32_32x32x16_bf16 v[40:55], v[128:131], v[124:127], v[40:55]
    s_add_u32 m0, s7, 126976
    s_mov_b32 s6, 491520
    v_mfma_f32_32x32x16_bf16 v[56:71], v[132:135], v[120:123], v[56:71]
    buffer_load_dwordx4 v7, s[8:11], s6 offen lds
    v_mfma_f32_32x32x16_bf16 v[72:87], v[132:135], v[124:127], v[72:87]
    v_mfma_f32_32x32x16_bf16 v[88:103], v[136:139], v[120:123], v[88:103]
    ds_read_b32 v22, v20 offset:0
    v_mfma_f32_32x32x16_bf16 v[104:119], v[136:139], v[124:127], v[104:119]
    s_add_u32 s47, s47, 88064
    s_setprio 2
    s_waitcnt lgkmcnt(0)
    v_readfirstlane_b32 s6, v22
    s_setprio 0
    s_cmp_ge_u32 s6, s50
    s_cbranch_scc1 G1_ok_34
LW_35:
    ds_read_b32 v22, v20 offset:0
    s_waitcnt lgkmcnt(0)
    v_readfirstlane_b32 s6, v22
    s_cmp_ge_u32 s6, s50
    s_cbranch_scc1 LWd_36
    s_sleep 1
    s_sub_u32 s98, s98, 1
    s_cbranch_scc0 LW_35
LWd_36:
G1_ok_34:
    v_mfma_f32_32x32x16_bf16 v[24:39], v[148:151], v[140:143], v[24:39]
    v_mfma_f32_32x32x16_bf16 v[40:55], v[148:151], v[144:147], v[40:55]
    v_mfma_f32_32x32x16_bf16 v[56:71], v[152:155], v[140:143], v[56:71]
    v_mfma_f32_32x32x16_bf16 v[72:87], v[152:155], v[144:147], v[72:87]
    v_mfma_f32_32x32x16_bf16 v[88:103], v[156:159], v[140:143], v[88:103]
    v_mfma_f32_32x32x16_bf16 v[104:119], v[156:159], v[144:147], v[104:119]
G1_done:
    s_setprio 2
    s_mul_i32 s44, s5, 11
    s_add_u32 s44, s44, s33
    s_lshl_b32 s45, s4, 11
    s_mov_b32 s7, s63
    s_add_u32 s12, s80, 5242880
    s_addc_u32 s13, s81, 0
    s_mov_b32 s14, 5636096
    s_mov_b32 s15, 0x20000
    s_mov_b32 s8, s72
    s_mov_b32 s9, s73
    s_mov_b32 s10, 1409024
    s_mov_b32 s11, 0x20000
    s_cmp_ge_u32 s44, 86
    s_cbranch_scc1 G1_skip_37
    s_lshl_b32 s46, s44, 16
    s_add_u32 s46, s46, s45
    v_pk_mul_f32 v[160:161], v[24:25], v[24:25]
    v_pk_mul_f32 v[162:163], v[26:27], v[26:27]
    v_pk_mul_f32 v[164:165], v[28:29], v[28:29]
    v_pk_mul_f32 v[166:167], v[30:31], v[30:31]
    v_pk_fma_f32 v[160:161], v[160:161], v[252:253], v[250:251]
    v_pk_fma_f32 v[162:163], v[162:163], v[252:253], v[250:251]
    v_pk_fma_f32 v[164:165], v[164:165], v[252:253], v[250:251]
    v_pk_fma_f32 v[166:167], v[166:167], v[252:253], v[250:251]
    v_pk_mul_f32 v[160:161], v[160:161], v[24:25]
    v_pk_mul_f32 v[162:163], v[162:163], v[26:27]
    v_pk_mul_f32 v[164:165], v[164:165], v[28:29]
    v_pk_mul_f32 v[166:167], v[166:167], v[30:31]
    s_add_u32 m0, s7, 0
    s_mov_b32 s6, 0
    buffer_load_dwordx4 v247, s[8:11], s6 offen lds
    v_exp_f32 v160, v160
    v_exp_f32 v161, v161
    v_exp_f32 v162, v162
    v_exp_f32 v163, v163
    v_exp_f32 v164, v164
    v_exp_f32 v165, v165
    v_exp_f32 v166, v166
    v_exp_f32 v167, v167
    s_add_u32 m0, s7, 1024
    s_mov_b32 s6, 8192
    buffer_load_dwordx4 v247, s[8:11], s6 offen lds
    v_pk_mul_f32 v[24:25], v[24:25], v[32:33]
    v_pk_mul_f32 v[26:27], v[26:27], v[34:35]
    v_pk_mul_f32 v[28:29], v[28:29], v[36:37]
    v_pk_mul_f32 v[30:31], v[30:31], v[38:39]
    v_pk_add_f32 v[160:161], v[160:161], v[254:255]
    v_pk_add_f32 v[162:163], v[162:163], v[254:255]
    v_pk_add_f32 v[164:165], v[164:165], v[254:255]
    v_pk_add_f32 v[166:167], v[166:167], v[254:255]
    s_add_u32 m0, s7, 2048
    s_mov_b32 s6, 65536
    buffer_load_dwordx4 v247, s[8:11], s6 offen lds
    v_rcp_f32 v160, v160
    v_rcp_f32 v161, v161
    v_rcp_f32 v162, v162
    v_rcp_f32 v163, v163
    v_rcp_f32 v164, v164
    v_rcp_f32 v165, v165
    v_rcp_f32 v166, v166
    v_rcp_f32 v167, v167
    s_add_u32 m0, s7, 3072
    s_mov_b32 s6, 73728
    buffer_load_dwordx4 v247, s[8:11], s6 offen lds
    s_nop 0
    v_pk_mul_f32 v[24:25], v[24:25], v[160:161]
    v_pk_mul_f32 v[26:27], v[26:27], v[162:163]
    v_pk_mul_f32 v[28:29], v[28:29], v[164:165]
    v_pk_mul_f32 v[30:31], v[30:31], v[166:167]
    v_cvt_pk_bf16_f32 v168, v24, v25
    v_cvt_pk_bf16_f32 v169, v26, v27
    v_cvt_pk_bf16_f32 v170, v28, v29
    v_cvt_pk_bf16_f32 v171, v30, v31
    buffer_store_dwordx4 v[168:171], v242, s[12:15], s46 offen offset:0 sc1
    v_pk_mul_f32 v[176:177], v[40:41], v[40:41]
    v_pk_mul_f32 v[178:179], v[42:43], v[42:43]
    v_pk_mul_f32 v[180:181], v[44:45], v[44:45]
    v_pk_mul_f32 v[182:183], v[46:47], v[46:47]
    v_pk_fma_f32 v[176:177], v[176:177], v[252:253], v[250:251]
    v_pk_fma_f32 v[178:179], v[178:179], v[252:253], v[250:251]
    v_pk_fma_f32 v[180:181], v[180:181], v[252:253], v[250:251]
    v_pk_fma_f32 v[182:183], v[182:183], v[252:253], v[250:251]
    v_pk_mul_f32 v[176:177], v[176:177], v[40:41]
    v_pk_mul_f32 v[178:179], v[178:179], v[42:43]
    v_pk_mul_f32 v[180:181], v[180:181], v[44:45]
    v_pk_mul_f32 v[182:183], v[182:183], v[46:47]
    s_add_u32 m0, s7, 4096
    s_mov_b32 s6, 131072
    buffer_load_dwordx4 v247, s[8:11], s6 offen lds
    v_exp_f32 v176, v176
    v_exp_f32 v177, v177
    v_exp_f32 v178, v178
    v_exp_f32 v179, v179
    v_exp_f32 v180, v180
    v_exp_f32 v181, v181
    v_exp_f32 v182, v182
    v_exp_f32 v183, v183
    s_add_u32 m0, s7, 5120
    s_mov_b32 s6, 139264
    buffer_load_dwordx4 v247, s[8:11], s6 offen lds
    v_pk_mul_f32 v[40:41], v[40:41], v[48:49]
    v_pk_mul_f32 v[42:43], v[42:43], v[50:51]
    v_pk_mul_f32 v[44:45], v[44:45], v[52:53]
    v_pk_mul_f32 v[46:47], v[46:47], v[54:55]
    v_pk_add_f32 v[176:177], v[176:177], v[254:255]
    v_pk_add_f32 v[178:179], v[178:179], v[254:255]
    v_pk_add_f32 v[180:181], v[180:181], v[254:255]
    v_pk_add_f32 v[182:183], v[182:183], v[254:255]
    s_add_u32 m0, s7, 6144
    s_mov_b32 s6, 196608
    buffer_load_dwordx4 v247, s[8:11], s6 offen lds
    v_rcp_f32 v176, v176
    v_rcp_f32 v177, v177
    v_rcp_f32 v178, v178
    v_rcp_f32 v179, v179
    v_rcp_f32 v180, v180
    v_rcp_f32 v181, v181
    v_rcp_f32 v182, v182
    v_rcp_f32 v183, v183
    s_add_u32 m0, s7, 7168
    s_mov_b32 s6, 204800
    buffer_load_dwordx4 v247, s[8:11], s6 offen lds
    s_nop 0
    v_pk_mul_f32 v[40:41], v[40:41], v[176:177]
    v_pk_mul_f32 v[42:43], v[42:43], v[178:179]
    v_pk_mul_f32 v[44:45], v[44:45], v[180:181]
    v_pk_mul_f32 v[46:47], v[46:47], v[182:183]
    v_cvt_pk_bf16_f32 v184, v40, v41
    v_cvt_pk_bf16_f32 v185, v42, v43
    v_cvt_pk_bf16_f32 v186, v44, v45
    v_cvt_pk_bf16_f32 v187, v46, v47
    buffer_store_dwordx4 v[184:187], v242, s[12:15], s46 offen offset:1024 sc1
G1_skip_37:
    s_add_u32 s44, s44, 4
    s_cmp_ge_u32 s44, 86
    s_cbranch_scc1 G1_skip_38
    s_lshl_b32 s46, s44, 16
    s_add_u32 s46, s46, s45
    v_pk_mul_f32 v[160:161], v[56:57], v[56:57]
    v_pk_mul_f32 v[162:163], v[58:59], v[58:59]
    v_pk_mul_f32 v[164:165], v[60:61], v[60:61]
    v_pk_mul_f32 v[166:167], v[62:63], v[62:63]
    v_pk_fma_f32 v[160:161], v[160:161], v[252:253], v[250:251]
    v_pk_fma_f32 v[162:163], v[162:163], v[252:253], v[250:251]
    v_pk_fma_f32 v[164:165], v[164:165], v[252:253], v[250:251]
    v_pk_fma_f32 v[166:167], v[166:167], v[252:253], v[250:251]
    v_pk_mul_f32 v[160:161], v[160:161], v[56:57]
    v_pk_mul_f32 v[162:163], v[162:163], v[58:59]
    v_pk_mul_f32 v[164:165], v[164:165], v[60:61]
    v_pk_mul_f32 v[166:167], v[166:167], v[62:63]
    s_add_u32 m0, s7, 8192
    s_mov_b32 s6, 262144
    buffer_load_dwordx4 v247, s[8:11], s6 offen lds
    v_exp_f32 v160, v160
    v_exp_f32 v161, v161
    v_exp_f32 v162, v162
    v_exp_f32 v163, v163
    v_exp_f32 v164, v164
    v_exp_f32 v165, v165
    v_exp_f32 v166, v166
    v_exp_f32 v167, v167
    s_add_u32 m0, s7, 9216
    s_mov_b32 s6, 270336
    buffer_load_dwordx4 v247, s[8:11], s6 offen lds
    v_pk_mul_f32 v[56:57], v[56:57], v[64:65]
    v_pk_mul_f32 v[58:59], v[58:59], v[66:67]
    v_pk_mul_f32 v[60:61], v[60:61], v[68:69]
    v_pk_mul_f32 v[62:63], v[62:63], v[70:71]
    v_pk_add_f32 v[160:161], v[160:161], v[254:255]
    v_pk_add_f32 v[162:163], v[162:163], v[254:255]
    v_pk_add_f32 v[164:165], v[164:165], v[254:255]
    v_pk_add_f32 v[166:167], v[166:167], v[254:255]
    s_add_u32 m0, s7, 10240
    s_mov_b32 s6, 327680
    buffer_load_dwordx4 v247, s[8:11], s6 offen lds
    v_rcp_f32 v160, v160
    v_rcp_f32 v161, v161
    v_rcp_f32 v162, v162
    v_rcp_f32 v163, v163
    v_rcp_f32 v164, v164
    v_rcp_f32 v165, v165
    v_rcp_f32 v166, v166
    v_rcp_f32 v167, v167
    s_add_u32 m0, s7, 11264
    s_mov_b32 s6, 335872
    buffer_load_dwordx4 v247, s[8:11], s6 offen lds
    s_nop 0
    v_pk_mul_f32 v[56:57], v[56:57], v[160:161]
    v_pk_mul_f32 v[58:59], v[58:59], v[162:163]
    v_pk_mul_f32 v[60:61], v[60:61], v[164:165]
    v_pk_mul_f32 v[62:63], v[62:63], v[166:167]
    v_cvt_pk_bf16_f32 v168, v56, v57
    v_cvt_pk_bf16_f32 v169, v58, v59
    v_cvt_pk_bf16_f32 v170, v60, v61
    v_cvt_pk_bf16_f32 v171, v62, v63
    buffer_store_dwordx4 v[168:171], v242, s[12:15], s46 offen offset:0 sc1
    v_pk_mul_f32 v[176:177], v[72:73], v[72:73]
    v_pk_mul_f32 v[178:179], v[74:75], v[74:75]
    v_pk_mul_f32 v[180:181], v[76:77], v[76:77]
    v_pk_mul_f32 v[182:183], v[78:79], v[78:79]
    v_pk_fma_f32 v[176:177], v[176:177], v[252:253], v[250:251]
    v_pk_fma_f32 v[178:179], v[178:179], v[252:253], v[250:251]
    v_pk_fma_f32 v[180:181], v[180:181], v[252:253], v[250:251]
    v_pk_fma_f32 v[182:183], v[182:183], v[252:253], v[250:251]
    v_pk_mul_f32 v[176:177], v[176:177], v[72:73]
    v_pk_mul_f32 v[178:179], v[178:179], v[74:75]
    v_pk_mul_f32 v[180:181], v[180:181], v[76:77]
    v_pk_mul_f32 v[182:183], v[182:183], v[78:79]
    s_add_u32 m0, s7, 12288
    s_mov_b32 s6, 393216
    buffer_load_dwordx4 v247, s[8:11], s6 offen lds
    v_exp_f32 v176, v176
    v_exp_f32 v177, v177
    v_exp_f32 v178, v178
    v_exp_f32 v179, v179
    v_exp_f32 v180, v180
    v_exp_f32 v181, v181
    v_exp_f32 v182, v182
    v_exp_f32 v183, v183
    s_add_u32 m0, s7, 13312
    s_mov_b32 s6, 401408
    buffer_load_dwordx4 v247, s[8:11], s6 offen lds
    v_pk_mul_f32 v[72:73], v[72:73], v[80:81]
    v_pk_mul_f32 v[74:75], v[74:75], v[82:83]
    v_pk_mul_f32 v[76:77], v[76:77], v[84:85]
    v_pk_mul_f32 v[78:79], v[78:79], v[86:87]
    v_pk_add_f32 v[176:177], v[176:177], v[254:255]
    v_pk_add_f32 v[178:179], v[178:179], v[254:255]
    v_pk_add_f32 v[180:181], v[180:181], v[254:255]
    v_pk_add_f32 v[182:183], v[182:183], v[254:255]
    s_add_u32 m0, s7, 14336
    s_mov_b32 s6, 458752
    buffer_load_dwordx4 v247, s[8:11], s6 offen lds
    v_rcp_f32 v176, v176
    v_rcp_f32 v177, v177
    v_rcp_f32 v178, v178
    v_rcp_f32 v179, v179
    v_rcp_f32 v180, v180
    v_rcp_f32 v181, v181
    v_rcp_f32 v182, v182
    v_rcp_f32 v183, v183
    s_add_u32 m0, s7, 15360
    s_mov_b32 s6, 466944
    buffer_load_dwordx4 v247, s[8:11], s6 offen lds
    s_nop 0
    v_pk_mul_f32 v[72:73], v[72:73], v[176:177]
    v_pk_mul_f32 v[74:75], v[74:75], v[178:179]
    v_pk_mul_f32 v[76:77], v[76:77], v[180:181]
    v_pk_mul_f32 v[78:79], v[78:79], v[182:183]
    v_cvt_pk_bf16_f32 v184, v72, v73
    v_cvt_pk_bf16_f32 v185, v74, v75
    v_cvt_pk_bf16_f32 v186, v76, v77
    v_cvt_pk_bf16_f32 v187, v78, v79
    buffer_store_dwordx4 v[184:187], v242, s[12:15], s46 offen offset:1024 sc1
G1_skip_38:
    s_add_u32 s44, s44, 4
    s_cmp_eq_u32 s33, 3
    s_cbranch_scc1 G1_skip_39
    s_cmp_ge_u32 s44, 86
    s_cbranch_scc1 G1_skip_39
    s_lshl_b32 s46, s44, 16
    s_add_u32 s46, s46, s45
    v_pk_mul_f32 v[160:161], v[88:89], v[88:89]
    v_pk_mul_f32 v[162:163], v[90:91], v[90:91]
    v_pk_mul_f32 v[164:165], v[92:93], v[92:93]
    v_pk_mul_f32 v[166:167], v[94:95], v[94:95]
    v_pk_fma_f32 v[160:161], v[160:161], v[252:253], v[250:251]
    v_pk_fma_f32 v[162:163], v[162:163], v[252:253], v[250:251]
    v_pk_fma_f32 v[164:165], v[164:165], v[252:253], v[250:251]
    v_pk_fma_f32 v[166:167], v[166:167], v[252:253], v[250:251]
    v_pk_mul_f32 v[160:161], v[160:161], v[88:89]
    v_pk_mul_f32 v[162:163], v[162:163], v[90:91]
    v_pk_mul_f32 v[164:165], v[164:165], v[92:93]
    v_pk_mul_f32 v[166:167], v[166:167], v[94:95]
    v_exp_f32 v160, v160
    v_exp_f32 v161, v161
    v_exp_f32 v162, v162
    v_exp_f32 v163, v163
    v_exp_f32 v164, v164
    v_exp_f32 v165, v165
    v_exp_f32 v166, v166
    v_exp_f32 v167, v167
    v_pk_mul_f32 v[88:89], v[88:89], v[96:97]
    v_pk_mul_f32 v[90:91], v[90:91], v[98:99]
    v_pk_mul_f32 v[92:93], v[92:93], v[100:101]
    v_pk_mul_f32 v[94:95], v[94:95], v[102:103]
    v_pk_add_f32 v[160:161], v[160:161], v[254:255]
    v_pk_add_f32 v[162:163], v[162:163], v[254:255]
    v_pk_add_f32 v[164:165], v[164:165], v[254:255]
    v_pk_add_f32 v[166:167], v[166:167], v[254:255]
    v_rcp_f32 v160, v160
    v_rcp_f32 v161, v161
    v_rcp_f32 v162, v162
    v_rcp_f32 v163, v163
    v_rcp_f32 v164, v164
    v_rcp_f32 v165, v165
    v_rcp_f32 v166, v166
    v_rcp_f32 v167, v167
    s_nop 0
    v_pk_mul_f32 v[88:89], v[88:89], v[160:161]
    v_pk_mul_f32 v[90:91], v[90:91], v[162:163]
    v_pk_mul_f32 v[92:93], v[92:93], v[164:165]
    v_pk_mul_f32 v[94:95], v[94:95], v[166:167]
    v_cvt_pk_bf16_f32 v168, v88, v89
    v_cvt_pk_bf16_f32 v169, v90, v91
    v_cvt_pk_bf16_f32 v170, v92, v93
    v_cvt_pk_bf16_f32 v171, v94, v95
    buffer_store_dwordx4 v[168:171], v242, s[12:15], s46 offen offset:0 sc1
    v_pk_mul_f32 v[176:177], v[104:105], v[104:105]
    v_pk_mul_f32 v[178:179], v[106:107], v[106:107]
    v_pk_mul_f32 v[180:181], v[108:109], v[108:109]
    v_pk_mul_f32 v[182:183], v[110:111], v[110:111]
    v_pk_fma_f32 v[176:177], v[176:177], v[252:253], v[250:251]
    v_pk_fma_f32 v[178:179], v[178:179], v[252:253], v[250:251]
    v_pk_fma_f32 v[180:181], v[180:181], v[252:253], v[250:251]
    v_pk_fma_f32 v[182:183], v[182:183], v[252:253], v[250:251]
    v_pk_mul_f32 v[176:177], v[176:177], v[104:105]
    v_pk_mul_f32 v[178:179], v[178:179], v[106:107]
    v_pk_mul_f32 v[180:181], v[180:181], v[108:109]
    v_pk_mul_f32 v[182:183], v[182:183], v[110:111]
    v_exp_f32 v176, v176
    v_exp_f32 v177, v177
    v_exp_f32 v178, v178
    v_exp_f32 v179, v179
    v_exp_f32 v180, v180
    v_exp_f32 v181, v181
    v_exp_f32 v182, v182
    v_exp_f32 v183, v183
    v_pk_mul_f32 v[104:105], v[104:105], v[112:113]
    v_pk_mul_f32 v[106:107], v[106:107], v[114:115]
    v_pk_mul_f32 v[108:109], v[108:109], v[116:117]
    v_pk_mul_f32 v[110:111], v[110:111], v[118:119]
    v_pk_add_f32 v[176:177], v[176:177], v[254:255]
    v_pk_add_f32 v[178:179], v[178:179], v[254:255]
    v_pk_add_f32 v[180:181], v[180:181], v[254:255]
    v_pk_add_f32 v[182:183], v[182:183], v[254:255]
    v_rcp_f32 v176, v176
    v_rcp_f32 v177, v177
    v_rcp_f32 v178, v178
    v_rcp_f32 v179, v179
    v_rcp_f32 v180, v180
    v_rcp_f32 v181, v181
    v_rcp_f32 v182, v182
    v_rcp_f32 v183, v183
    s_nop 0
    v_pk_mul_f32 v[104:105], v[104:105], v[176:177]
    v_pk_mul_f32 v[106:107], v[106:107], v[178:179]
    v_pk_mul_f32 v[108:109], v[108:109], v[180:181]
    v_pk_mul_f32 v[110:111], v[110:111], v[182:183]
    v_cvt_pk_bf16_f32 v184, v104, v105
    v_cvt_pk_bf16_f32 v185, v106, v107
    v_cvt_pk_bf16_f32 v186, v108, v109
    v_cvt_pk_bf16_f32 v187, v110, v111
    buffer_store_dwordx4 v[184:187], v242, s[12:15], s46 offen offset:1024 sc1
G1_skip_39:
    s_add_u32 s44, s44, 4
    s_lshl_b32 s42, s4, 1
    s_add_u32 s42, s42, s61
    s_lshl_b32 s43, s42, 7
    s_add_u32 s24, s80, 4390912
    s_addc_u32 s25, s81, 0
    s_mov_b32 s26, 8192
    s_mov_b32 s27, 0x20000
    s_add_u32 s28, s80, 4423680
    s_addc_u32 s29, s81, 0
    s_mov_b32 s30, 139264
    s_mov_b32 s31, 0x20000
    s_waitcnt vmcnt(0)
    s_mov_b64 exec, 1
    ds_add_u32 v20, v21 offset:0
    s_mov_b64 exec, -1
    s_add_u32 s50, s50, 4
LW_40:
    ds_read_b32 v22, v20 offset:0
    s_waitcnt lgkmcnt(0)
    v_readfirstlane_b32 s6, v22
    s_cmp_ge_u32 s6, s50
    s_cbranch_scc1 LWd_41
    s_sleep 1
    s_sub_u32 s98, s98, 1
    s_cbranch_scc0 LW_40
LWd_41:
    s_cmp_lg_u32 s33, 0
    s_cbranch_scc1 G2_nopub
    s_lshl_b32 s6, s4, 5
    s_add_u32 s6, s6, s5
    s_lshl_b32 s6, s6, 2
    s_add_u32 s6, s6, 4096
    v_mov_b32 v13, s54
    v_mov_b32 v14, 0
    s_mov_b64 exec, 1
    buffer_store_dword v13, v14, s[28:31], s6 offen sc1
    s_mov_b64 exec, -1
G2_nopub:
    s_lshl_b32 s6, s33, 13
    s_sub_u32 s6, s6, 98304
    v_add_u32 v250, s6, v234
    v_add_u32 v251, s6, v235
    v_add_u32 v252, s6, v236
    v_add_u32 v253, s6, v237
    s_lshl_b32 s48, s4, 7
    s_add_u32 s48, s48, 0x1000
    s_cmp_eq_u32 s33, 0
    s_cselect_b32 s44, 0xff, 1
    s_mov_b32 s45, 0
    s_setprio 0
    ds_read_b32 v22, v20 offset:8
    s_waitcnt vmcnt(63)
    ds_read_b64_tr_b16 v[152:153], v244 offset:0
    ds_read_b64_tr_b16 v[154:155], v244 offset:1024
    ds_read_b64_tr_b16 v[156:157], v245 offset:0
    ds_read_b64_tr_b16 v[158:159], v245 offset:1024
    ds_read_b64_tr_b16 v[160:161], v244 offset:2048
    ds_read_b64_tr_b16 v[162:163], v244 offset:3072
    ds_read_b64_tr_b16 v[164:165], v245 offset:2048
    ds_read_b64_tr_b16 v[166:167], v245 offset:3072
    ds_read_b64_tr_b16 v[168:169], v244 offset:4096
    ds_read_b64_tr_b16 v[170:171], v244 offset:5120
    ds_read_b64_tr_b16 v[172:173], v245 offset:4096
    ds_read_b64_tr_b16 v[174:175], v245 offset:5120
    s_waitcnt lgkmcnt(8)
    ds_read_b64_tr_b16 v[176:177], v244 offset:6144
    ds_read_b64_tr_b16 v[178:179], v244 offset:7168
    ds_read_b64_tr_b16 v[180:181], v245 offset:6144
    ds_read_b64_tr_b16 v[182:183], v245 offset:7168
    s_waitcnt lgkmcnt(8)
    ds_read_b64_tr_b16 v[184:185], v244 offset:8192
    ds_read_b64_tr_b16 v[186:187], v244 offset:9216
    ds_read_b64_tr_b16 v[188:189], v245 offset:8192
    ds_read_b64_tr_b16 v[190:191], v245 offset:9216
    s_waitcnt lgkmcnt(8)
    ds_read_b64_tr_b16 v[192:193], v244 offset:10240
    ds_read_b64_tr_b16 v[194:195], v244 offset:11264
    ds_read_b64_tr_b16 v[196:197], v245 offset:10240
    ds_read_b64_tr_b16 v[198:199], v245 offset:11264
    s_waitcnt lgkmcnt(8)
    ds_read_b64_tr_b16 v[200:201], v244 offset:12288
    ds_read_b64_tr_b16 v[202:203], v244 offset:13312
    ds_read_b64_tr_b16 v[204:205], v245 offset:12288
    ds_read_b64_tr_b16 v[206:207], v245 offset:13312
    s_waitcnt lgkmcnt(8)
    ds_read_b64_tr_b16 v[208:209], v244 offset:14336
    ds_read_b64_tr_b16 v[210:211], v244 offset:15360
    ds_read_b64_tr_b16 v[212:213], v245 offset:14336
    ds_read_b64_tr_b16 v[214:215], v245 offset:15360
    s_waitcnt lgkmcnt(0)
    s_add_u32 m0, s7, 0
    s_mov_b32 s6, 524288
    buffer_load_dwordx4 v247, s[8:11], s6 offen lds
    s_add_u32 m0, s7, 1024
    s_mov_b32 s6, 532480
    buffer_load_dwordx4 v247, s[8:11], s6 offen lds
    s_add_u32 m0, s7, 2048
    s_mov_b32 s6, 589824
    buffer_load_dwordx4 v247, s[8:11], s6 offen lds
    s_add_u32 m0, s7, 3072
    s_mov_b32 s6, 598016
    buffer_load_dwordx4 v247, s[8:11], s6 offen lds
    s_waitcnt vmcnt(8)
    s_add_u32 m0, s7, 4096
    s_mov_b32 s6, 655360
    buffer_load_dwordx4 v247, s[8:11], s6 offen lds
    s_add_u32 m0, s7, 5120
    s_mov_b32 s6, 663552
    buffer_load_dwordx4 v247, s[8:11], s6 offen lds
    s_waitcnt vmcnt(8)
    s_add_u32 m0, s7, 6144
    s_mov_b32 s6, 720896
    buffer_load_dwordx4 v247, s[8:11], s6 offen lds
    s_add_u32 m0, s7, 7168
    s_mov_b32 s6, 729088
    buffer_load_dwordx4 v247, s[8:11], s6 offen lds
    s_waitcnt vmcnt(8)
    s_add_u32 m0, s7, 8192
    s_mov_b32 s6, 786432
    buffer_load_dwordx4 v247, s[8:11], s6 offen lds
    s_add_u32 m0, s7, 9216
    s_mov_b32 s6, 794624
    buffer_load_dwordx4 v247, s[8:11], s6 offen lds
    s_waitcnt vmcnt(8)
    s_add_u32 m0, s7, 10240
    s_mov_b32 s6, 851968
    buffer_load_dwordx4 v247, s[8:11], s6 offen lds
    s_add_u32 m0, s7, 11264
    s_mov_b32 s6, 860160
    buffer_load_dwordx4 v247, s[8:11], s6 offen lds
    s_waitcnt vmcnt(8)
    s_mov_b64 exec, s[44:45]
    buffer_load_dword v14, v249, s[28:31], s48 offen sc1
    s_mov_b64 exec, -1
    s_add_u32 m0, s7, 12288
    s_mov_b32 s6, 917504
    buffer_load_dwordx4 v247, s[8:11], s6 offen lds
    s_add_u32 m0, s7, 13312
    s_mov_b32 s6, 925696
    buffer_load_dwordx4 v247, s[8:11], s6 offen lds
    s_waitcnt vmcnt(8)
    s_add_u32 m0, s7, 14336
    s_mov_b32 s6, 983040
    buffer_load_dwordx4 v247, s[8:11], s6 offen lds
    s_add_u32 m0, s7, 15360
    s_mov_b32 s6, 991232
    buffer_load_dwordx4 v247, s[8:11], s6 offen lds
    s_waitcnt vmcnt(8)
    s_setprio 2
    v_readfirstlane_b32 s54, v22
    s_cmp_lg_u32 s33, 0
    s_cbranch_scc1 G2_wait
    s_waitcnt vmcnt(4)
    s_mov_b64 exec, 0xff
    v_cmp_ne_u32 vcc, s54, v14
    s_mov_b64 exec, -1
    s_cbranch_vccz G2_post
    s_lshl_b32 s6, s4, 7
    s_add_u32 s6, s6, 4096
    v_and_b32 v13, 7, v1
    v_lshlrev_b32 v13, 2, v13
    s_mov_b32 s55, 200000
PG_42:
    buffer_load_dword v14, v13, s[28:31], s6 offen sc1
    s_waitcnt vmcnt(0)
    v_cmp_ne_u32 vcc, s54, v14
    s_cbranch_vccz PGd_43
    s_sleep 4
    s_sub_u32 s55, s55, 1
    s_cmp_lg_u32 s55, 0
    s_cbranch_scc1 PG_42
PGd_43:
G2_post:
    ds_write_b32 v20, v21 offset:12
    s_branch G2_go
G2_wait:
LW_44:
    ds_read_b32 v22, v20 offset:12
    s_waitcnt lgkmcnt(0)
    v_readfirstlane_b32 s6, v22
    s_cmp_ge_u32 s6, 1
    s_cbranch_scc1 LWd_45
    s_sleep 2
    s_sub_u32 s98, s98, 1
    s_cbranch_scc0 LW_44
LWd_45:
G2_go:
    s_setprio 0
    buffer_load_dword v12, v246, s[24:27], s43 offen sc1
    s_mov_b32 s6, 0
    buffer_load_dwordx4 v[88:91], v243, s[12:15], s6 offen offset:0 sc1
    buffer_load_dwordx4 v[92:95], v243, s[12:15], s6 offen offset:1024 sc1
    s_mov_b32 s6, 262144
    buffer_load_dwordx4 v[96:99], v243, s[12:15], s6 offen offset:0 sc1
    buffer_load_dwordx4 v[100:103], v243, s[12:15], s6 offen offset:1024 sc1
    s_mov_b32 s6, 524288
    buffer_load_dwordx4 v[104:107], v243, s[12:15], s6 offen offset:0 sc1
    buffer_load_dwordx4 v[108:111], v243, s[12:15], s6 offen offset:1024 sc1
    s_mov_b32 s6, 786432
    buffer_load_dwordx4 v[112:115], v243, s[12:15], s6 offen offset:0 sc1
    buffer_load_dwordx4 v[116:119], v243, s[12:15], s6 offen offset:1024 sc1
    s_waitcnt vmcnt(6)
    v_mfma_f32_32x32x16_bf16 v[24:39], v[152:155], v[88:91], 0
    v_mfma_f32_32x32x16_bf16 v[40:55], v[152:155], v[92:95], 0
    v_mfma_f32_32x32x16_bf16 v[56:71], v[156:159], v[88:91], 0
    s_mov_b32 s6, 1048576
    buffer_load_dwordx4 v[120:123], v243, s[12:15], s6 offen offset:0 sc1
    v_mfma_f32_32x32x16_bf16 v[72:87], v[156:159], v[92:95], 0
    buffer_load_dwordx4 v[124:127], v243, s[12:15], s6 offen offset:1024 sc1
    s_waitcnt vmcnt(6)
    v_mfma_f32_32x32x16_bf16 v[24:39], v[160:163], v[96:99], v[24:39]
    v_mfma_f32_32x32x16_bf16 v[40:55], v[160:163], v[100:103], v[40:55]
    v_mfma_f32_32x32x16_bf16 v[56:71], v[164:167], v[96:99], v[56:71]
    s_mov_b32 s6, 1310720
    buffer_load_dwordx4 v[128:131], v243, s[12:15], s6 offen offset:0 sc1
    v_mfma_f32_32x32x16_bf16 v[72:87], v[164:167], v[100:103], v[72:87]
    buffer_load_dwordx4 v[132:135], v243, s[12:15], s6 offen offset:1024 sc1
    s_waitcnt vmcnt(6)
    v_mfma_f32_32x32x16_bf16 v[24:39], v[168:171], v[104:107], v[24:39]
    v_mfma_f32_32x32x16_bf16 v[40:55], v[168:171], v[108:111], v[40:55]
    v_mfma_f32_32x32x16_bf16 v[56:71], v[172:175], v[104:107], v[56:71]
    s_mov_b32 s6, 1572864
    buffer_load_dwordx4 v[136:139], v243, s[12:15], s6 offen offset:0 sc1
    v_mfma_f32_32x32x16_bf16 v[72:87], v[172:175], v[108:111], v[72:87]
    buffer_load_dwordx4 v[140:143], v243, s[12:15], s6 offen offset:1024 sc1
    s_waitcnt vmcnt(6)
    v_mfma_f32_32x32x16_bf16 v[24:39], v[176:179], v[112:115], v[24:39]
    v_mfma_f32_32x32x16_bf16 v[40:55], v[176:179], v[116:119], v[40:55]
    v_mfma_f32_32x32x16_bf16 v[56:71], v[180:183], v[112:115], v[56:71]
    s_mov_b32 s6, 1835008
    buffer_load_dwordx4 v[144:147], v243, s[12:15], s6 offen offset:0 sc1
    v_mfma_f32_32x32x16_bf16 v[72:87], v[180:183], v[116:119], v[72:87]
    buffer_load_dwordx4 v[148:151], v243, s[12:15], s6 offen offset:1024 sc1
    s_waitcnt vmcnt(6)
    v_mfma_f32_32x32x16_bf16 v[24:39], v[184:187], v[120:123], v[24:39]
    v_mfma_f32_32x32x16_bf16 v[40:55], v[184:187], v[124:127], v[40:55]
    v_mfma_f32_32x32x16_bf16 v[56:71], v[188:191], v[120:123], v[56:71]
    s_mov_b32 s6, 2097152
    buffer_load_dwordx4 v[88:91], v243, s[12:15], s6 offen offset:0 sc1
    v_mfma_f32_32x32x16_bf16 v[72:87], v[188:191], v[124:127], v[72:87]
    buffer_load_dwordx4 v[92:95], v243, s[12:15], s6 offen offset:1024 sc1
    s_waitcnt vmcnt(6)
    v_mfma_f32_32x32x16_bf16 v[24:39], v[192:195], v[128:131], v[24:39]
    v_mfma_f32_32x32x16_bf16 v[40:55], v[192:195], v[132:135], v[40:55]
    v_mfma_f32_32x32x16_bf16 v[56:71], v[196:199], v[128:131], v[56:71]
    s_mov_b32 s6, 2359296
    buffer_load_dwordx4 v[96:99], v243, s[12:15], s6 offen offset:0 sc1
    v_mfma_f32_32x32x16_bf16 v[72:87], v[196:199], v[132:135], v[72:87]
    buffer_load_dwordx4 v[100:103], v243, s[12:15], s6 offen offset:1024 sc1
    s_waitcnt vmcnt(6)
    v_mfma_f32_32x32x16_bf16 v[24:39], v[200:203], v[136:139], v[24:39]
    v_mfma_f32_32x32x16_bf16 v[40:55], v[200:203], v[140:143], v[40:55]
    v_mfma_f32_32x32x16_bf16 v[56:71], v[204:207], v[136:139], v[56:71]
    s_mov_b32 s6, 2621440
    buffer_load_dwordx4 v[104:107], v243, s[12:15], s6 offen offset:0 sc1
    v_mfma_f32_32x32x16_bf16 v[72:87], v[204:207], v[140:143], v[72:87]
    buffer_load_dwordx4 v[108:111], v243, s[12:15], s6 offen offset:1024 sc1
    s_waitcnt vmcnt(6)
    ds_read_b64_tr_b16 v[152:153], v244 offset:0
    ds_read_b64_tr_b16 v[154:155], v244 offset:1024
    ds_read_b64_tr_b16 v[156:157], v245 offset:0
    ds_read_b64_tr_b16 v[158:159], v245 offset:1024
    v_mfma_f32_32x32x16_bf16 v[24:39], v[208:211], v[144:147], v[24:39]
    v_mfma_f32_32x32x16_bf16 v[40:55], v[208:211], v[148:151], v[40:55]
    v_mfma_f32_32x32x16_bf16 v[56:71], v[212:215], v[144:147], v[56:71]
    s_mov_b32 s6, 2883584
    buffer_load_dwordx4 v[112:115], v243, s[12:15], s6 offen offset:0 sc1
    v_mfma_f32_32x32x16_bf16 v[72:87], v[212:215], v[148:151], v[72:87]
    buffer_load_dwordx4 v[116:119], v243, s[12:15], s6 offen offset:1024 sc1
    s_waitcnt vmcnt(6)
    ds_read_b64_tr_b16 v[160:161], v244 offset:2048
    ds_read_b64_tr_b16 v[162:163], v244 offset:3072
    ds_read_b64_tr_b16 v[164:165], v245 offset:2048
    ds_read_b64_tr_b16 v[166:167], v245 offset:3072
    s_waitcnt lgkmcnt(4)
    v_mfma_f32_32x32x16_bf16 v[24:39], v[152:155], v[88:91], v[24:39]
    s_add_u32 m0, s7, 0
    s_mov_b32 s6, 1048576
    buffer_load_dwordx4 v247, s[8:11], s6 offen lds
    v_mfma_f32_32x32x16_bf16 v[40:55], v[152:155], v[92:95], v[40:55]
    s_add_u32 m0, s7, 1024
    s_mov_b32 s6, 1056768
    buffer_load_dwordx4 v247, s[8:11], s6 offen lds
    v_mfma_f32_32x32x16_bf16 v[56:71], v[156:159], v[88:91], v[56:71]
    s_mov_b32 s6, 3145728
    buffer_load_dwordx4 v[120:123], v243, s[12:15], s6 offen offset:0 sc1
    v_mfma_f32_32x32x16_bf16 v[72:87], v[156:159], v[92:95], v[72:87]
    buffer_load_dwordx4 v[124:127], v243, s[12:15], s6 offen offset:1024 sc1
    s_waitcnt vmcnt(8)
    ds_read_b64_tr_b16 v[152:153], v244 offset:4096
    ds_read_b64_tr_b16 v[154:155], v244 offset:5120
    ds_read_b64_tr_b16 v[156:157], v245 offset:4096
    ds_read_b64_tr_b16 v[158:159], v245 offset:5120
    s_waitcnt lgkmcnt(4)
    v_mfma_f32_32x32x16_bf16 v[24:39], v[160:163], v[96:99], v[24:39]
    s_add_u32 m0, s7, 2048
    s_mov_b32 s6, 1114112
    buffer_load_dwordx4 v247, s[8:11], s6 offen lds
    v_mfma_f32_32x32x16_bf16 v[40:55], v[160:163], v[100:103], v[40:55]
    s_add_u32 m0, s7, 3072
    s_mov_b32 s6, 1122304
    buffer_load_dwordx4 v247, s[8:11], s6 offen lds
    v_mfma_f32_32x32x16_bf16 v[56:71], v[164:167], v[96:99], v[56:71]
    s_mov_b32 s6, 3407872
    buffer_load_dwordx4 v[128:131], v243, s[12:15], s6 offen offset:0 sc1
    v_mfma_f32_32x32x16_bf16 v[72:87], v[164:167], v[100:103], v[72:87]
    buffer_load_dwordx4 v[132:135], v243, s[12:15], s6 offen offset:1024 sc1
    s_waitcnt vmcnt(10)
    ds_read_b64_tr_b16 v[160:161], v244 offset:6144
    ds_read_b64_tr_b16 v[162:163], v244 offset:7168
    ds_read_b64_tr_b16 v[164:165], v245 offset:6144
    ds_read_b64_tr_b16 v[166:167], v245 offset:7168
    s_waitcnt lgkmcnt(4)
    ds_read_b64_tr_b16 v[168:169], v232 offset:0
    ds_read_b64_tr_b16 v[170:171], v232 offset:1024
    ds_read_b64_tr_b16 v[172:173], v233 offset:0
    ds_read_b64_tr_b16 v[174:175], v233 offset:1024
    v_mfma_f32_32x32x16_bf16 v[24:39], v[152:155], v[104:107], v[24:39]
    s_add_u32 m0, s7, 4096
    s_mov_b32 s6, 1179648
    buffer_load_dwordx4 v247, s[8:11], s6 offen lds
    v_mfma_f32_32x32x16_bf16 v[40:55], v[152:155], v[108:111], v[40:55]
    s_add_u32 m0, s7, 5120
    s_mov_b32 s6, 1187840
    buffer_load_dwordx4 v247, s[8:11], s6 offen lds
    v_mfma_f32_32x32x16_bf16 v[56:71], v[156:159], v[104:107], v[56:71]
    s_mov_b32 s6, 3670016
    buffer_load_dwordx4 v[136:139], v243, s[12:15], s6 offen offset:0 sc1
    v_mfma_f32_32x32x16_bf16 v[72:87], v[156:159], v[108:111], v[72:87]
    buffer_load_dwordx4 v[140:143], v243, s[12:15], s6 offen offset:1024 sc1
    s_waitcnt vmcnt(12)
    ds_read_b64_tr_b16 v[152:153], v244 offset:8192
    ds_read_b64_tr_b16 v[154:155], v244 offset:9216
    ds_read_b64_tr_b16 v[156:157], v245 offset:8192
    ds_read_b64_tr_b16 v[158:159], v245 offset:9216
    s_waitcnt lgkmcnt(4)
    ds_read_b64_tr_b16 v[176:177], v232 offset:2048
    ds_read_b64_tr_b16 v[178:179], v232 offset:3072
    ds_read_b64_tr_b16 v[180:181], v233 offset:2048
    ds_read_b64_tr_b16 v[182:183], v233 offset:3072
    v_mfma_f32_32x32x16_bf16 v[24:39], v[160:163], v[112:115], v[24:39]
    s_add_u32 m0, s7, 6144
    s_mov_b32 s6, 1245184
    buffer_load_dwordx4 v247, s[8:11], s6 offen lds
    v_mfma_f32_32x32x16_bf16 v[40:55], v[160:163], v[116:119], v[40:55]
    s_add_u32 m0, s7, 7168
    s_mov_b32 s6, 1253376
    buffer_load_dwordx4 v247, s[8:11], s6 offen lds
    v_mfma_f32_32x32x16_bf16 v[56:71], v[164:167], v[112:115], v[56:71]
    s_mov_b32 s6, 3932160
    buffer_load_dwordx4 v[144:147], v243, s[12:15], s6 offen offset:0 sc1
    v_mfma_f32_32x32x16_bf16 v[72:87], v[164:167], v[116:119], v[72:87]
    buffer_load_dwordx4 v[148:151], v243, s[12:15], s6 offen offset:1024 sc1
    s_waitcnt vmcnt(12)
    ds_read_b64_tr_b16 v[160:161], v244 offset:10240
    ds_read_b64_tr_b16 v[162:163], v244 offset:11264
    ds_read_b64_tr_b16 v[164:165], v245 offset:10240
    ds_read_b64_tr_b16 v[166:167], v245 offset:11264
    s_waitcnt lgkmcnt(4)
    ds_read_b64_tr_b16 v[184:185], v232 offset:4096
    ds_read_b64_tr_b16 v[186:187], v232 offset:5120
    ds_read_b64_tr_b16 v[188:189], v233 offset:4096
    ds_read_b64_tr_b16 v[190:191], v233 offset:5120
    v_mfma_f32_32x32x16_bf16 v[24:39], v[152:155], v[120:123], v[24:39]
    s_add_u32 m0, s7, 8192
    s_mov_b32 s6, 1310720
    buffer_load_dwordx4 v247, s[8:11], s6 offen lds
    v_mfma_f32_32x32x16_bf16 v[40:55], v[152:155], v[124:127], v[40:55]
    s_add_u32 m0, s7, 9216
    s_mov_b32 s6, 1318912
    buffer_load_dwordx4 v247, s[8:11], s6 offen lds
    v_mfma_f32_32x32x16_bf16 v[56:71], v[156:159], v[120:123], v[56:71]
    s_mov_b32 s6, 4194304
    buffer_load_dwordx4 v[88:91], v243, s[12:15], s6 offen offset:0 sc1
    v_mfma_f32_32x32x16_bf16 v[72:87], v[156:159], v[124:127], v[72:87]
    buffer_load_dwordx4 v[92:95], v243, s[12:15], s6 offen offset:1024 sc1
    s_waitcnt vmcnt(12)
    ds_read_b64_tr_b16 v[152:153], v244 offset:12288
    ds_read_b64_tr_b16 v[154:155], v244 offset:13312
    ds_read_b64_tr_b16 v[156:157], v245 offset:12288
    ds_read_b64_tr_b16 v[158:159], v245 offset:13312
    s_waitcnt lgkmcnt(4)
    ds_read_b64_tr_b16 v[192:193], v232 offset:6144
    ds_read_b64_tr_b16 v[194:195], v232 offset:7168
    ds_read_b64_tr_b16 v[196:197], v233 offset:6144
    ds_read_b64_tr_b16 v[198:199], v233 offset:7168
    v_mfma_f32_32x32x16_bf16 v[24:39], v[160:163], v[128:131], v[24:39]
    s_add_u32 m0, s7, 10240
    s_mov_b32 s6, 1376256
    buffer_load_dwordx4 v247, s[8:11], s6 offen lds
    v_mfma_f32_32x32x16_bf16 v[40:55], v[160:163], v[132:135], v[40:55]
    s_add_u32 m0, s7, 11264
    s_mov_b32 s6, 1384448
    buffer_load_dwordx4 v247, s[8:11], s6 offen lds
    v_mfma_f32_32x32x16_bf16 v[56:71], v[164:167], v[128:131], v[56:71]
    s_mov_b32 s6, 4456448
    buffer_load_dwordx4 v[96:99], v243, s[12:15], s6 offen offset:0 sc1
    v_mfma_f32_32x32x16_bf16 v[72:87], v[164:167], v[132:135], v[72:87]
    buffer_load_dwordx4 v[100:103], v243, s[12:15], s6 offen offset:1024 sc1
    s_waitcnt vmcnt(12)
    ds_read_b64_tr_b16 v[160:161], v244 offset:14336
    ds_read_b64_tr_b16 v[162:163], v244 offset:15360
    ds_read_b64_tr_b16 v[164:165], v245 offset:14336
    ds_read_b64_tr_b16 v[166:167], v245 offset:15360
    s_waitcnt lgkmcnt(4)
    ds_read_b64_tr_b16 v[200:201], v232 offset:8192
    ds_read_b64_tr_b16 v[202:203], v232 offset:9216
    ds_read_b64_tr_b16 v[204:205], v233 offset:8192
    ds_read_b64_tr_b16 v[206:207], v233 offset:9216
    v_mfma_f32_32x32x16_bf16 v[24:39], v[152:155], v[136:139], v[24:39]
    v_mfma_f32_32x32x16_bf16 v[40:55], v[152:155], v[140:143], v[40:55]
    v_mfma_f32_32x32x16_bf16 v[56:71], v[156:159], v[136:139], v[56:71]
    s_mov_b32 s6, 4718592
    buffer_load_dwordx4 v[104:107], v243, s[12:15], s6 offen offset:0 sc1
    v_mfma_f32_32x32x16_bf16 v[72:87], v[156:159], v[140:143], v[72:87]
    buffer_load_dwordx4 v[108:111], v243, s[12:15], s6 offen offset:1024 sc1
    s_waitcnt vmcnt(10)
    ds_read_b64_tr_b16 v[152:153], v244 offset:0
    ds_read_b64_tr_b16 v[154:155], v244 offset:1024
    ds_read_b64_tr_b16 v[156:157], v245 offset:0
    ds_read_b64_tr_b16 v[158:159], v245 offset:1024
    s_waitcnt lgkmcnt(4)
    ds_read_b64_tr_b16 v[208:209], v232 offset:10240
    ds_read_b64_tr_b16 v[210:211], v232 offset:11264
    ds_read_b64_tr_b16 v[212:213], v233 offset:10240
    ds_read_b64_tr_b16 v[214:215], v233 offset:11264
    v_mfma_f32_32x32x16_bf16 v[24:39], v[160:163], v[144:147], v[24:39]
    v_mfma_f32_32x32x16_bf16 v[40:55], v[160:163], v[148:151], v[40:55]
    v_mfma_f32_32x32x16_bf16 v[56:71], v[164:167], v[144:147], v[56:71]
    s_mov_b32 s6, 4980736
    buffer_load_dwordx4 v[112:115], v243, s[12:15], s6 offen offset:0 sc1
    v_mfma_f32_32x32x16_bf16 v[72:87], v[164:167], v[148:151], v[72:87]
    buffer_load_dwordx4 v[116:119], v243, s[12:15], s6 offen offset:1024 sc1
    s_waitcnt vmcnt(8)
    ds_read_b64_tr_b16 v[160:161], v244 offset:2048
    ds_read_b64_tr_b16 v[162:163], v244 offset:3072
    ds_read_b64_tr_b16 v[164:165], v245 offset:2048
    ds_read_b64_tr_b16 v[166:167], v245 offset:3072
    s_waitcnt lgkmcnt(4)
    ds_read_b64_tr_b16 v[216:217], v232 offset:12288
    ds_read_b64_tr_b16 v[218:219], v232 offset:13312
    ds_read_b64_tr_b16 v[220:221], v233 offset:12288
    ds_read_b64_tr_b16 v[222:223], v233 offset:13312
    v_mfma_f32_32x32x16_bf16 v[24:39], v[152:155], v[88:91], v[24:39]
    v_mfma_f32_32x32x16_bf16 v[40:55], v[152:155], v[92:95], v[40:55]
    v_mfma_f32_32x32x16_bf16 v[56:71], v[156:159], v[88:91], v[56:71]
    s_mov_b32 s6, 5242880
    buffer_load_dwordx4 v[120:123], v243, s[12:15], s6 offen offset:0 sc1
    v_mfma_f32_32x32x16_bf16 v[72:87], v[156:159], v[92:95], v[72:87]
    buffer_load_dwordx4 v[124:127], v243, s[12:15], s6 offen offset:1024 sc1
    s_waitcnt vmcnt(6)
    ds_read_b64_tr_b16 v[152:153], v244 offset:4096
    ds_read_b64_tr_b16 v[154:155], v244 offset:5120
    ds_read_b64_tr_b16 v[156:157], v245 offset:4096
    ds_read_b64_tr_b16 v[158:159], v245 offset:5120
    s_waitcnt lgkmcnt(4)
    ds_read_b64_tr_b16 v[224:225], v232 offset:14336
    ds_read_b64_tr_b16 v[226:227], v232 offset:15360
    ds_read_b64_tr_b16 v[228:229], v233 offset:14336
    ds_read_b64_tr_b16 v[230:231], v233 offset:15360
    v_mfma_f32_32x32x16_bf16 v[24:39], v[160:163], v[96:99], v[24:39]
    v_mfma_f32_32x32x16_bf16 v[40:55], v[160:163], v[100:103], v[40:55]
    v_mfma_f32_32x32x16_bf16 v[56:71], v[164:167], v[96:99], v[56:71]
    s_mov_b32 s6, 5505024
    buffer_load_dwordx4 v[128:131], v243, s[12:15], s6 offen offset:0 sc1
    v_mfma_f32_32x32x16_bf16 v[72:87], v[164:167], v[100:103], v[72:87]
    buffer_load_dwordx4 v[132:135], v243, s[12:15], s6 offen offset:1024 sc1
    s_waitcnt vmcnt(6)
    ds_read_b64_tr_b16 v[160:161], v244 offset:6144
    ds_read_b64_tr_b16 v[162:163], v244 offset:7168
    ds_read_b64_tr_b16 v[164:165], v245 offset:6144
    ds_read_b64_tr_b16 v[166:167], v245 offset:7168
    s_waitcnt lgkmcnt(4)
    s_add_u32 s20, s80, 2097152
    s_addc_u32 s21, s81, 0
    s_mov_b32 s22, 2097152
    s_mov_b32 s23, 0x20000
    v_mfma_f32_32x32x16_bf16 v[24:39], v[152:155], v[104:107], v[24:39]
    v_mfma_f32_32x32x16_bf16 v[40:55], v[152:155], v[108:111], v[40:55]
    v_mfma_f32_32x32x16_bf16 v[56:71], v[156:159], v[104:107], v[56:71]
    v_mfma_f32_32x32x16_bf16 v[72:87], v[156:159], v[108:111], v[72:87]
    s_waitcnt vmcnt(4)
    ds_read_b64_tr_b16 v[152:153], v244 offset:8192
    ds_read_b64_tr_b16 v[154:155], v244 offset:9216
    ds_read_b64_tr_b16 v[156:157], v245 offset:8192
    ds_read_b64_tr_b16 v[158:159], v245 offset:9216
    s_waitcnt lgkmcnt(4)
    s_mov_b32 s24, s76
    s_mov_b32 s25, s77
    s_mov_b32 s26, 2097152
    s_mov_b32 s27, 0x20000
    v_mfma_f32_32x32x16_bf16 v[24:39], v[160:163], v[112:115], v[24:39]
    v_mfma_f32_32x32x16_bf16 v[40:55], v[160:163], v[116:119], v[40:55]
    v_mfma_f32_32x32x16_bf16 v[56:71], v[164:167], v[112:115], v[56:71]
    v_mfma_f32_32x32x16_bf16 v[72:87], v[164:167], v[116:119], v[72:87]
    s_waitcnt vmcnt(2)
    ds_read_b64_tr_b16 v[160:161], v244 offset:10240
    ds_read_b64_tr_b16 v[162:163], v244 offset:11264
    ds_read_b64_tr_b16 v[164:165], v245 offset:10240
    ds_read_b64_tr_b16 v[166:167], v245 offset:11264
    s_waitcnt lgkmcnt(4)
    v_mfma_f32_32x32x16_bf16 v[24:39], v[152:155], v[120:123], v[24:39]
    v_mfma_f32_32x32x16_bf16 v[40:55], v[152:155], v[124:127], v[40:55]
    v_mfma_f32_32x32x16_bf16 v[56:71], v[156:159], v[120:123], v[56:71]
    v_mfma_f32_32x32x16_bf16 v[72:87], v[156:159], v[124:127], v[72:87]
    s_waitcnt vmcnt(0)
    s_waitcnt lgkmcnt(0)
    v_mfma_f32_32x32x16_bf16 v[24:39], v[160:163], v[128:131], v[24:39]
    v_mfma_f32_32x32x16_bf16 v[40:55], v[160:163], v[132:135], v[40:55]
    v_mfma_f32_32x32x16_bf16 v[56:71], v[164:167], v[128:131], v[56:71]
    v_mfma_f32_32x32x16_bf16 v[72:87], v[164:167], v[132:135], v[72:87]
    s_mov_b32 s46, s54
    ds_write_b32 v240, v12
    s_nop 10
    ds_write_b128 v250, v[24:27] offset:0
    ds_write_b128 v251, v[28:31] offset:0
    ds_write_b128 v252, v[32:35] offset:0
    ds_write_b128 v253, v[36:39] offset:0
    ds_write_b128 v250, v[40:43] offset:8192
    ds_write_b128 v251, v[44:47] offset:8192
    ds_write_b128 v252, v[48:51] offset:8192
    ds_write_b128 v253, v[52:55] offset:8192
    ds_write_b128 v250, v[56:59] offset:128
    ds_write_b128 v251, v[60:63] offset:128
    ds_write_b128 v252, v[64:67] offset:128
    ds_write_b128 v253, v[68:71] offset:128
    ds_write_b128 v250, v[72:75] offset:8320
    ds_write_b128 v251, v[76:79] offset:8320
    ds_write_b128 v252, v[80:83] offset:8320
    ds_write_b128 v253, v[84:87] offset:8320
TAIL:
    s_mov_b32 s47, 200000
    s_waitcnt lgkmcnt(0)
    s_barrier
    s_mov_b64 exec, 15
    buffer_load_dword v17, v241, s[28:31], s60 offen sc1
    s_mov_b64 exec, -1
    v_xor_b32 v3, 16, v238
    v_lshrrev_b32 v13, 8, v238
    v_lshlrev_b32 v13, 2, v13
    v_add_u32 v4, 65536, v238
    v_add_u32 v5, 65536, v3
    v_add_u32 v13, 160384, v13
    ds_read_b32 v13, v13
    ds_read_b128 v[88:91], v238 offset:0
    ds_read_b128 v[92:95], v3 offset:0
    ds_read_b128 v[96:99], v238 offset:16384
    ds_read_b128 v[100:103], v3 offset:16384
    ds_read_b128 v[104:107], v238 offset:32768
    ds_read_b128 v[108:111], v3 offset:32768
    ds_read_b128 v[112:115], v238 offset:49152
    ds_read_b128 v[116:119], v3 offset:49152
    s_waitcnt lgkmcnt(0)
    v_sub_f32 v16, 1.0, v13
    v_add_f32 v88, v88, v96
    v_add_f32 v104, v104, v112
    v_add_f32 v89, v89, v97
    v_add_f32 v105, v105, v113
    v_add_f32 v90, v90, v98
    v_add_f32 v106, v106, v114
    v_add_f32 v91, v91, v99
    v_add_f32 v107, v107, v115
    v_add_f32 v92, v92, v100
    v_add_f32 v108, v108, v116
    v_add_f32 v93, v93, v101
    v_add_f32 v109, v109, v117
    v_add_f32 v94, v94, v102
    v_add_f32 v110, v110, v118
    v_add_f32 v95, v95, v103
    v_add_f32 v111, v111, v119
    v_add_f32 v88, v88, v104
    v_add_f32 v89, v89, v105
    v_add_f32 v90, v90, v106
    v_add_f32 v91, v91, v107
    v_add_f32 v92, v92, v108
    v_add_f32 v93, v93, v109
    v_add_f32 v94, v94, v110
    v_add_f32 v95, v95, v111
    v_mul_f32 v88, v88, v16
    v_mul_f32 v89, v89, v16
    v_mul_f32 v90, v90, v16
    v_mul_f32 v91, v91, v16
    v_mul_f32 v92, v92, v16
    v_mul_f32 v93, v93, v16
    v_mul_f32 v94, v94, v16
    v_mul_f32 v95, v95, v16
    s_mov_b64 exec, 15
T_poll_46:
    s_waitcnt vmcnt(0)
    v_cmp_ne_u32 vcc, s46, v17
    s_cbranch_vccz T_polld_47
    s_sleep 2
    buffer_load_dword v17, v241, s[28:31], s60 offen sc1
    s_sub_u32 s47, s47, 1
    s_cbranch_scc0 T_poll_46
T_polld_47:
    s_mov_b64 exec, -1
    buffer_load_dwordx4 v[56:59], v242, s[20:23], s57 offen offset:0 sc1
    buffer_load_dwordx4 v[60:63], v242, s[20:23], s57 offen offset:1024 sc1
    buffer_load_dwordx4 v[64:67], v242, s[20:23], s57 offen offset:2048 sc1
    buffer_load_dwordx4 v[68:71], v242, s[20:23], s57 offen offset:3072 sc1
    buffer_load_dwordx4 v[72:75], v242, s[20:23], s58 offen offset:0 sc1
    buffer_load_dwordx4 v[76:79], v242, s[20:23], s58 offen offset:1024 sc1
    buffer_load_dwordx4 v[80:83], v242, s[20:23], s58 offen offset:2048 sc1
    buffer_load_dwordx4 v[84:87], v242, s[20:23], s58 offen offset:3072 sc1
    s_waitcnt vmcnt(7)
    v_mfma_f32_32x32x16_bf16 v[24:39], v[168:171], v[56:59], 0
    v_mfma_f32_32x32x16_bf16 v[40:55], v[172:175], v[56:59], 0
    s_waitcnt vmcnt(6)
    v_mfma_f32_32x32x16_bf16 v[24:39], v[176:179], v[60:63], v[24:39]
    v_mfma_f32_32x32x16_bf16 v[40:55], v[180:183], v[60:63], v[40:55]
    s_waitcnt vmcnt(5)
    v_mfma_f32_32x32x16_bf16 v[24:39], v[184:187], v[64:67], v[24:39]
    v_mfma_f32_32x32x16_bf16 v[40:55], v[188:191], v[64:67], v[40:55]
    s_waitcnt vmcnt(4)
    v_mfma_f32_32x32x16_bf16 v[24:39], v[192:195], v[68:71], v[24:39]
    v_mfma_f32_32x32x16_bf16 v[40:55], v[196:199], v[68:71], v[40:55]
    s_waitcnt vmcnt(3)
    v_mfma_f32_32x32x16_bf16 v[24:39], v[200:203], v[72:75], v[24:39]
    v_mfma_f32_32x32x16_bf16 v[40:55], v[204:207], v[72:75], v[40:55]
    s_waitcnt vmcnt(2)
    v_mfma_f32_32x32x16_bf16 v[24:39], v[208:211], v[76:79], v[24:39]
    v_mfma_f32_32x32x16_bf16 v[40:55], v[212:215], v[76:79], v[40:55]
    s_waitcnt vmcnt(1)
    v_mfma_f32_32x32x16_bf16 v[24:39], v[216:219], v[80:83], v[24:39]
    v_mfma_f32_32x32x16_bf16 v[40:55], v[220:223], v[80:83], v[40:55]
    s_waitcnt vmcnt(0)
    v_mfma_f32_32x32x16_bf16 v[24:39], v[224:227], v[84:87], v[24:39]
    v_mfma_f32_32x32x16_bf16 v[40:55], v[228:231], v[84:87], v[40:55]
    s_nop 10
    ds_write_b128 v234, v[24:27] offset:0
    ds_write_b128 v235, v[28:31] offset:0
    ds_write_b128 v236, v[32:35] offset:0
    ds_write_b128 v237, v[36:39] offset:0
    ds_write_b128 v234, v[40:43] offset:128
    ds_write_b128 v235, v[44:47] offset:128
    ds_write_b128 v236, v[48:51] offset:128
    ds_write_b128 v237, v[52:55] offset:128
    s_waitcnt lgkmcnt(0)
    s_barrier
    ds_read_b128 v[168:171], v4 offset:0
    ds_read_b128 v[172:175], v5 offset:0
    ds_read_b128 v[176:179], v4 offset:16384
    ds_read_b128 v[180:183], v5 offset:16384
    ds_read_b128 v[184:187], v4 offset:32768
    ds_read_b128 v[188:191], v5 offset:32768
    ds_read_b128 v[192:195], v4 offset:49152
    ds_read_b128 v[196:199], v5 offset:49152
    s_waitcnt lgkmcnt(4)
    v_add_f32 v168, v168, v176
    v_add_f32 v169, v169, v177
    v_add_f32 v170, v170, v178
    v_add_f32 v171, v171, v179
    v_add_f32 v172, v172, v180
    v_add_f32 v173, v173, v181
    v_add_f32 v174, v174, v182
    v_add_f32 v175, v175, v183
    s_waitcnt lgkmcnt(0)
    v_add_f32 v184, v184, v192
    v_add_f32 v185, v185, v193
    v_add_f32 v186, v186, v194
    v_add_f32 v187, v187, v195
    v_add_f32 v188, v188, v196
    v_add_f32 v189, v189, v197
    v_add_f32 v190, v190, v198
    v_add_f32 v191, v191, v199
    v_add_f32 v168, v168, v184
    v_add_f32 v169, v169, v185
    v_add_f32 v170, v170, v186
    v_add_f32 v171, v171, v187
    v_add_f32 v172, v172, v188
    v_add_f32 v173, v173, v189
    v_add_f32 v174, v174, v190
    v_add_f32 v175, v175, v191
    v_fma_f32 v168, v168, v13, v88
    v_fma_f32 v169, v169, v13, v89
    v_fma_f32 v170, v170, v13, v90
    v_fma_f32 v171, v171, v13, v91
    v_fma_f32 v172, v172, v13, v92
    v_fma_f32 v173, v173, v13, v93
    v_fma_f32 v174, v174, v13, v94
    v_fma_f32 v175, v175, v13, v95
    v_cvt_pk_bf16_f32 v24, v168, v169
    v_cvt_pk_bf16_f32 v25, v170, v171
    v_cvt_pk_bf16_f32 v26, v172, v173
    v_cvt_pk_bf16_f32 v27, v174, v175
    buffer_store_dwordx4 v[24:27], v239, s[24:27], s59 offen nt
M_end:
    s_endpgm
F_oth:
    s_mov_b64 exec, 1
    ds_add_u32 v20, v21 offset:56
    s_mov_b64 exec, -1
    v_lshrrev_b32 v2, 3, v1
    v_and_b32 v3, 7, v1
    v_bfe_u32 v6, v2, 1, 1
    v_lshlrev_b32 v6, 2, v6
    v_xor_b32 v6, v6, v3
    v_lshlrev_b32 v6, 4, v6
    v_lshl_add_u32 v23, v2, 10, v6
    s_lshl_b32 s6, s5, 7
    v_add_u32 v23, s6, v23
    s_mul_i32 s44, s5, 352
    s_movk_i32 s46, 2400
    s_lshl_b32 s45, s33, 6
    s_add_u32 s34, s7, 65536
    s_add_u32 s35, s34, 4096
    s_add_u32 s37, s34, 12416
    s_add_u32 s38, s34, 16512
    s_cmp_eq_u32 s33, 3
    s_cselect_b32 s6, 128, 0
    s_cselect_b32 s42, 704, 0
    s_sub_u32 s42, 512, s42
    s_add_u32 s36, s34, s6
    s_add_u32 s36, s36, 8192
    s_cmp_ge_u32 s33, 2
    s_cselect_b32 s6, 0, 20608
    s_cselect_b32 s43, 0, 576
    s_add_u32 s39, s34, s6
    s_cmp_ge_u32 s33, 2
    s_cselect_b32 s39, 163840, s39
    v_add_u32 v5, s45, v1
    v_add_u32 v2, 0, v5
    v_mul_u32_u24 v3, 2979, v2
    v_lshrrev_b32 v3, 16, v3
    v_lshl_add_u32 v2, v2, 4, s44
    v_mad_u32_u24 v8, v3, s46, v2
    v_add_u32 v2, 256, v5
    v_mul_u32_u24 v3, 2979, v2
    v_lshrrev_b32 v3, 16, v3
    v_lshl_add_u32 v2, v2, 4, s44
    v_mad_u32_u24 v9, v3, s46, v2
    v_add_u32 v2, s42, v5
    v_mul_u32_u24 v3, 2979, v2
    v_lshrrev_b32 v3, 16, v3
    v_lshl_add_u32 v2, v2, 4, s44
    v_mad_u32_u24 v10, v3, s46, v2
    v_add_u32 v2, 64, v5
    v_mul_u32_u24 v3, 2979, v2
    v_lshrrev_b32 v3, 16, v3
    v_lshl_add_u32 v2, v2, 4, s44
    v_mad_u32_u24 v11, v3, s46, v2
    v_add_u32 v2, 320, v5
    v_mul_u32_u24 v3, 2979, v2
    v_lshrrev_b32 v3, 16, v3
    v_lshl_add_u32 v2, v2, 4, s44
    v_mad_u32_u24 v12, v3, s46, v2
    v_add_u32 v2, s43, v5
    v_mul_u32_u24 v3, 2979, v2
    v_lshrrev_b32 v3, 16, v3
    v_lshl_add_u32 v2, v2, 4, s44
    v_mad_u32_u24 v13, v3, s46, v2
    v_and_b32 v2, 31, v1
    v_lshrrev_b32 v3, 5, v1
    v_bfe_u32 v5, v2, 1, 3
    v_lshlrev_b32 v2, 7, v2
    v_or_b32 v6, 0, v3
    v_xor_b32 v6, v6, v5
    v_lshl_add_u32 v14, v6, 4, v2
    v_or_b32 v6, 2, v3
    v_xor_b32 v6, v6, v5
    v_lshl_add_u32 v15, v6, 4, v2
    v_or_b32 v6, 4, v3
    v_xor_b32 v6, v6, v5
    v_lshl_add_u32 v16, v6, 4, v2
    v_or_b32 v6, 6, v3
    v_xor_b32 v6, v6, v5
    v_lshl_add_u32 v17, v6, 4, v2
    v_bfe_u32 v2, v1, 2, 2
    v_lshl_add_u32 v2, v3, 3, v2
    v_mul_u32_u24 v2, 352, v2
    v_bfe_u32 v3, v1, 4, 1
    v_mul_u32_u24 v3, 11392, v3
    v_add_u32 v2, v2, v3
    v_and_b32 v3, 3, v1
    v_lshl_add_u32 v2, v3, 3, v2
    s_lshl_b32 s6, s33, 5
    s_add_u32 s6, s6, 65536
    v_add_u32 v18, s6, v2
    v_add_u32 v19, 45312, v18
    s_mov_b32 s47, 0
    s_mov_b32 s12, s68
    s_mov_b32 s13, s69
    s_mov_b32 s14, 1409024
    s_mov_b32 s15, 0x20000
    s_mov_b32 s16, s70
    s_mov_b32 s17, s71
    s_mov_b32 s18, 1409024
    s_mov_b32 s19, 0x20000
    s_cmp_eq_u32 s33, 3
    s_cselect_b32 s42, s70, s68
    s_cselect_b32 s43, s71, s69
    s_mov_b32 s20, s42
    s_mov_b32 s21, s43
    s_mov_b32 s22, 1409024
    s_mov_b32 s23, 0x20000
    s_cmp_ge_u32 s33, 2
    s_cselect_b32 s42, s68, s70
    s_cselect_b32 s43, s69, s71
    s_mov_b32 s24, s42
    s_mov_b32 s25, s43
    s_mov_b32 s26, 1409024
    s_mov_b32 s27, 0x20000
    s_cselect_b32 s26, 0, s26
    s_waitcnt vmcnt(0)
    s_mov_b64 exec, 1
    ds_add_u32 v20, v21 offset:60
    s_mov_b64 exec, -1
    s_cmp_lg_u32 s33, 1
    s_cbranch_scc1 F_join
    s_cmp_ge_u32 s5, 4
    s_cbranch_scc1 F_join
    s_lshl_b32 s6, s55, 4
    v_and_b32 v205, 15, v1
    v_add_u32 v200, s6, v205
    v_lshrrev_b32 v206, 4, v1
    v_bfe_u32 v5, v200, 1, 3
    v_xor_b32 v5, v5, v206
    v_lshlrev_b32 v5, 4, v5
    v_lshl_add_u32 v201, v200, 7, v5
    v_xor_b32 v202, 64, v201
    v_lshlrev_b32 v204, 4, v206
    v_add_u32 v204, 81920, v204
    s_add_u32 s28, s80, 4390912
    s_addc_u32 s29, s81, 0
    s_mov_b32 s30, 8192
    s_mov_b32 s31, 0x20000
LW_1:
    ds_read_b32 v22, v20 offset:60
    s_waitcnt lgkmcnt(0)
    v_readfirstlane_b32 s6, v22
    s_cmp_ge_u32 s6, 4
    s_cbranch_scc1 LWd_2
    s_sleep 1
    s_sub_u32 s98, s98, 1
    s_cbranch_scc0 LW_1
LWd_2:
    ds_read_b128 v[24:27], v201 offset:0
    ds_read_b128 v[28:31], v204 offset:0
    ds_read_b128 v[32:35], v202 offset:0
    ds_read_b128 v[36:39], v204 offset:64
    ds_read_b128 v[40:43], v201 offset:8192
    ds_read_b128 v[44:47], v204 offset:128
    ds_read_b128 v[48:51], v202 offset:8192
    ds_read_b128 v[52:55], v204 offset:192
    ds_read_b128 v[56:59], v201 offset:16384
    ds_read_b128 v[60:63], v204 offset:256
    ds_read_b128 v[64:67], v202 offset:16384
    ds_read_b128 v[68:71], v204 offset:320
    ds_read_b128 v[72:75], v201 offset:24576
    ds_read_b128 v[76:79], v204 offset:384
    s_waitcnt lgkmcnt(12)
    v_mfma_f32_16x16x32_bf16 v[212:215], v[28:31], v[24:27], 0
    ds_read_b128 v[80:83], v202 offset:24576
    ds_read_b128 v[84:87], v204 offset:448
    s_waitcnt lgkmcnt(12)
    v_mfma_f32_16x16x32_bf16 v[212:215], v[36:39], v[32:35], v[212:215]
    ds_read_b128 v[24:27], v201 offset:32768
    ds_read_b128 v[28:31], v204 offset:512
    s_waitcnt lgkmcnt(12)
    v_mfma_f32_16x16x32_bf16 v[212:215], v[44:47], v[40:43], v[212:215]
    ds_read_b128 v[32:35], v202 offset:32768
    ds_read_b128 v[36:39], v204 offset:576
    s_waitcnt lgkmcnt(12)
    v_mfma_f32_16x16x32_bf16 v[212:215], v[52:55], v[48:51], v[212:215]
    ds_read_b128 v[40:43], v201 offset:40960
    ds_read_b128 v[44:47], v204 offset:640
    s_waitcnt lgkmcnt(12)
    v_mfma_f32_16x16x32_bf16 v[212:215], v[60:63], v[56:59], v[212:215]
    ds_read_b128 v[48:51], v202 offset:40960
    ds_read_b128 v[52:55], v204 offset:704
    s_waitcnt lgkmcnt(12)
    v_mfma_f32_16x16x32_bf16 v[212:215], v[68:71], v[64:67], v[212:215]
    ds_read_b128 v[56:59], v201 offset:49152
    ds_read_b128 v[60:63], v204 offset:768
    s_waitcnt lgkmcnt(12)
    v_mfma_f32_16x16x32_bf16 v[212:215], v[76:79], v[72:75], v[212:215]
    ds_read_b128 v[64:67], v202 offset:49152
    ds_read_b128 v[68:71], v204 offset:832
    s_waitcnt lgkmcnt(12)
    v_mfma_f32_16x16x32_bf16 v[212:215], v[84:87], v[80:83], v[212:215]
    ds_read_b128 v[72:75], v201 offset:57344
    ds_read_b128 v[76:79], v204 offset:896
    s_waitcnt lgkmcnt(12)
    v_mfma_f32_16x16x32_bf16 v[212:215], v[28:31], v[24:27], v[212:215]
    ds_read_b128 v[80:83], v202 offset:57344
    ds_read_b128 v[84:87], v204 offset:960
    s_waitcnt lgkmcnt(12)
    v_mfma_f32_16x16x32_bf16 v[212:215], v[36:39], v[32:35], v[212:215]
    s_waitcnt lgkmcnt(10)
    v_mfma_f32_16x16x32_bf16 v[212:215], v[44:47], v[40:43], v[212:215]
    s_waitcnt lgkmcnt(8)
    v_mfma_f32_16x16x32_bf16 v[212:215], v[52:55], v[48:51], v[212:215]
    s_waitcnt lgkmcnt(6)
    v_mfma_f32_16x16x32_bf16 v[212:215], v[60:63], v[56:59], v[212:215]
    s_waitcnt lgkmcnt(4)
    v_mfma_f32_16x16x32_bf16 v[212:215], v[68:71], v[64:67], v[212:215]
    s_waitcnt lgkmcnt(2)
    v_mfma_f32_16x16x32_bf16 v[212:215], v[76:79], v[72:75], v[212:215]
    s_waitcnt lgkmcnt(0)
    v_mfma_f32_16x16x32_bf16 v[212:215], v[84:87], v[80:83], v[212:215]
    s_lshl_b32 s6, s4, 8
    v_lshlrev_b32 v5, 2, v200
    s_nop 6
    v_mul_f32 v212, 0xbfb8aa3b, v212
    v_exp_f32 v212, v212
    s_nop 0
    v_add_f32 v212, 1.0, v212
    v_rcp_f32 v212, v212
    s_mov_b64 exec, 0xffff
    s_nop 0
    buffer_store_dword v212, v5, s[28:31], s6 offen sc1
    s_mov_b64 exec, -1
    s_branch F_join
G1L_start:
    s_setprio 0
    ds_read_b128 v[120:123], v14 offset:0
    ds_read_b128 v[124:127], v14 offset:4096
    ds_read_b64_tr_b16 v[128:129], v18 offset:0
    ds_read_b64_tr_b16 v[130:131], v18 offset:1408
    ds_read_b64_tr_b16 v[132:133], v18 offset:128
    ds_read_b64_tr_b16 v[134:135], v18 offset:1536
    s_add_u32 m0, s34, 45312
    s_nop 0
    buffer_load_dwordx4 v8, s[12:15], s47 offen lds
    s_add_u32 m0, s35, 45312
    s_nop 0
    buffer_load_dwordx4 v9, s[12:15], s47 offen lds
    s_add_u32 m0, s36, 45312
    s_nop 0
    buffer_load_dwordx4 v10, s[20:23], s47 offen lds
    s_add_u32 m0, s37, 45312
    s_nop 0
    buffer_load_dwordx4 v11, s[16:19], s47 offen lds
    s_add_u32 m0, s38, 45312
    s_nop 0
    buffer_load_dwordx4 v12, s[16:19], s47 offen lds
    s_add_u32 m0, s39, 45312
    s_nop 0
    buffer_load_dwordx4 v13, s[24:27], s47 offen lds
    s_add_u32 s47, s47, 88064
    ds_read_b128 v[140:143], v15 offset:0
    ds_read_b128 v[144:147], v15 offset:4096
    ds_read_b64_tr_b16 v[148:149], v18 offset:5632
    ds_read_b64_tr_b16 v[150:151], v18 offset:7040
    ds_read_b64_tr_b16 v[152:153], v18 offset:5760
    ds_read_b64_tr_b16 v[154:155], v18 offset:7168
    s_waitcnt vmcnt(6)
    ds_add_u32 v5, v21
    s_add_u32 s50, s50, 4
    s_waitcnt lgkmcnt(7)
    s_add_u32 m0, s34, 67968
    v_mfma_f32_32x32x16_bf16 v[24:39], v[128:131], v[120:123], v[24:39]
    buffer_load_dwordx4 v8, s[12:15], s47 offen lds
    s_add_u32 m0, s35, 67968
    v_mfma_f32_32x32x16_bf16 v[40:55], v[128:131], v[124:127], v[40:55]
    buffer_load_dwordx4 v9, s[12:15], s47 offen lds
    s_add_u32 m0, s36, 67968
    v_mfma_f32_32x32x16_bf16 v[56:71], v[132:135], v[120:123], v[56:71]
    buffer_load_dwordx4 v10, s[20:23], s47 offen lds
    s_add_u32 m0, s37, 67968
    v_mfma_f32_32x32x16_bf16 v[72:87], v[132:135], v[124:127], v[72:87]
    buffer_load_dwordx4 v11, s[16:19], s47 offen lds
    s_add_u32 m0, s38, 67968
    s_nop 0
    buffer_load_dwordx4 v12, s[16:19], s47 offen lds
    s_add_u32 m0, s39, 67968
    s_nop 0
    buffer_load_dwordx4 v13, s[24:27], s47 offen lds
    s_add_u32 s47, s47, 88064
    s_setprio 2
LW_11_L:
    ds_read_b32 v22, v20 offset:0
    s_waitcnt lgkmcnt(0)
    v_readfirstlane_b32 s6, v22
    s_cmp_ge_u32 s6, s50
    s_cbranch_scc1 LWd_12_L
    s_sleep 2
    s_sub_u32 s98, s98, 1
    s_cbranch_scc0 LW_11_L
LWd_12_L:
    s_setprio 0
    s_branch G1_mid_L
.p2align 6
G1_loop_L:
    ds_read_b128 v[120:123], v14 offset:0
    ds_read_b128 v[124:127], v14 offset:4096
    ds_read_b64_tr_b16 v[128:129], v18 offset:0
    ds_read_b64_tr_b16 v[130:131], v18 offset:1408
    ds_read_b64_tr_b16 v[132:133], v18 offset:128
    ds_read_b64_tr_b16 v[134:135], v18 offset:1536
    s_add_u32 m0, s34, 67968
    v_mfma_f32_32x32x16_bf16 v[24:39], v[148:151], v[140:143], v[24:39]
    buffer_load_dwordx4 v8, s[12:15], s47 offen lds
    v_mfma_f32_32x32x16_bf16 v[40:55], v[148:151], v[144:147], v[40:55]
    s_add_u32 m0, s35, 67968
    v_mfma_f32_32x32x16_bf16 v[56:71], v[152:155], v[140:143], v[56:71]
    buffer_load_dwordx4 v9, s[12:15], s47 offen lds
    v_mfma_f32_32x32x16_bf16 v[72:87], v[152:155], v[144:147], v[72:87]
    s_add_u32 m0, s36, 67968
    s_nop 0
    buffer_load_dwordx4 v10, s[20:23], s47 offen lds
    ds_read_b128 v[140:143], v15 offset:0
    ds_read_b128 v[144:147], v15 offset:4096
    ds_read_b64_tr_b16 v[148:149], v18 offset:5632
    ds_read_b64_tr_b16 v[150:151], v18 offset:7040
    ds_read_b64_tr_b16 v[152:153], v18 offset:5760
    ds_read_b64_tr_b16 v[154:155], v18 offset:7168
    s_waitcnt vmcnt(9)
    ds_add_u32 v5, v21
    s_add_u32 s50, s50, 4
    s_waitcnt lgkmcnt(7)
    s_add_u32 m0, s37, 67968
    v_mfma_f32_32x32x16_bf16 v[24:39], v[128:131], v[120:123], v[24:39]
    buffer_load_dwordx4 v11, s[16:19], s47 offen lds
    v_mfma_f32_32x32x16_bf16 v[40:55], v[128:131], v[124:127], v[40:55]
    s_add_u32 m0, s38, 67968
    v_mfma_f32_32x32x16_bf16 v[56:71], v[132:135], v[120:123], v[56:71]
    buffer_load_dwordx4 v12, s[16:19], s47 offen lds
    v_mfma_f32_32x32x16_bf16 v[72:87], v[132:135], v[124:127], v[72:87]
    s_add_u32 m0, s39, 67968
    s_nop 0
    buffer_load_dwordx4 v13, s[24:27], s47 offen lds
    ds_read_b32 v22, v20 offset:0
    s_add_u32 s47, s47, 88064
    s_setprio 2
    s_waitcnt lgkmcnt(0)
    v_readfirstlane_b32 s6, v22
    s_setprio 0
    s_cmp_ge_u32 s6, s50
    s_cbranch_scc1 G1_ok_13_L
LW_14_L:
    ds_read_b32 v22, v20 offset:0
    s_waitcnt lgkmcnt(0)
    v_readfirstlane_b32 s6, v22
    s_cmp_ge_u32 s6, s50
    s_cbranch_scc1 LWd_15_L
    s_sleep 2
    s_sub_u32 s98, s98, 1
    s_cbranch_scc0 LW_14_L
LWd_15_L:
G1_ok_13_L:
G1_mid_L:
    ds_read_b128 v[120:123], v16 offset:0
    ds_read_b128 v[124:127], v16 offset:4096
    ds_read_b64_tr_b16 v[128:129], v18 offset:22656
    ds_read_b64_tr_b16 v[130:131], v18 offset:24064
    ds_read_b64_tr_b16 v[132:133], v18 offset:22784
    ds_read_b64_tr_b16 v[134:135], v18 offset:24192
    s_add_u32 m0, s34, 0
    v_mfma_f32_32x32x16_bf16 v[24:39], v[148:151], v[140:143], v[24:39]
    buffer_load_dwordx4 v8, s[12:15], s47 offen lds
    v_mfma_f32_32x32x16_bf16 v[40:55], v[148:151], v[144:147], v[40:55]
    s_add_u32 m0, s35, 0
    v_mfma_f32_32x32x16_bf16 v[56:71], v[152:155], v[140:143], v[56:71]
    buffer_load_dwordx4 v9, s[12:15], s47 offen lds
    v_mfma_f32_32x32x16_bf16 v[72:87], v[152:155], v[144:147], v[72:87]
    s_add_u32 m0, s36, 0
    s_nop 0
    buffer_load_dwordx4 v10, s[20:23], s47 offen lds
    ds_read_b128 v[140:143], v17 offset:0
    ds_read_b128 v[144:147], v17 offset:4096
    ds_read_b64_tr_b16 v[148:149], v18 offset:28288
    ds_read_b64_tr_b16 v[150:151], v18 offset:29696
    ds_read_b64_tr_b16 v[152:153], v18 offset:28416
    ds_read_b64_tr_b16 v[154:155], v18 offset:29824
    s_waitcnt vmcnt(9)
    ds_add_u32 v5, v21
    s_add_u32 s50, s50, 4
    s_waitcnt lgkmcnt(7)
    s_add_u32 m0, s37, 0
    v_mfma_f32_32x32x16_bf16 v[24:39], v[128:131], v[120:123], v[24:39]
    buffer_load_dwordx4 v11, s[16:19], s47 offen lds
    v_mfma_f32_32x32x16_bf16 v[40:55], v[128:131], v[124:127], v[40:55]
    s_add_u32 m0, s38, 0
    v_mfma_f32_32x32x16_bf16 v[56:71], v[132:135], v[120:123], v[56:71]
    buffer_load_dwordx4 v12, s[16:19], s47 offen lds
    v_mfma_f32_32x32x16_bf16 v[72:87], v[132:135], v[124:127], v[72:87]
    s_add_u32 m0, s39, 0
    s_nop 0
    buffer_load_dwordx4 v13, s[24:27], s47 offen lds
    ds_read_b32 v22, v20 offset:0
    s_add_u32 s47, s47, 88064
    s_setprio 2
    s_waitcnt lgkmcnt(0)
    v_readfirstlane_b32 s6, v22
    s_setprio 0
    s_cmp_ge_u32 s6, s50
    s_cbranch_scc1 G1_ok_16_L
LW_17_L:
    ds_read_b32 v22, v20 offset:0
    s_waitcnt lgkmcnt(0)
    v_readfirstlane_b32 s6, v22
    s_cmp_ge_u32 s6, s50
    s_cbranch_scc1 LWd_18_L
    s_sleep 2
    s_sub_u32 s98, s98, 1
    s_cbranch_scc0 LW_17_L
LWd_18_L:
G1_ok_16_L:
    ds_read_b128 v[120:123], v14 offset:8192
    ds_read_b128 v[124:127], v14 offset:12288
    ds_read_b64_tr_b16 v[128:129], v19 offset:0
    ds_read_b64_tr_b16 v[130:131], v19 offset:1408
    ds_read_b64_tr_b16 v[132:133], v19 offset:128
    ds_read_b64_tr_b16 v[134:135], v19 offset:1536
    s_add_u32 m0, s34, 22656
    v_mfma_f32_32x32x16_bf16 v[24:39], v[148:151], v[140:143], v[24:39]
    buffer_load_dwordx4 v8, s[12:15], s47 offen lds
    v_mfma_f32_32x32x16_bf16 v[40:55], v[148:151], v[144:147], v[40:55]
    s_add_u32 m0, s35, 22656
    v_mfma_f32_32x32x16_bf16 v[56:71], v[152:155], v[140:143], v[56:71]
    buffer_load_dwordx4 v9, s[12:15], s47 offen lds
    v_mfma_f32_32x32x16_bf16 v[72:87], v[152:155], v[144:147], v[72:87]
    s_add_u32 m0, s36, 22656
    s_nop 0
    buffer_load_dwordx4 v10, s[20:23], s47 offen lds
    ds_read_b128 v[140:143], v15 offset:8192
    ds_read_b128 v[144:147], v15 offset:12288
    ds_read_b64_tr_b16 v[148:149], v19 offset:5632
    ds_read_b64_tr_b16 v[150:151], v19 offset:7040
    ds_read_b64_tr_b16 v[152:153], v19 offset:5760
    ds_read_b64_tr_b16 v[154:155], v19 offset:7168
    s_waitcnt vmcnt(9)
    ds_add_u32 v5, v21
    s_add_u32 s50, s50, 4
    s_waitcnt lgkmcnt(7)
    s_add_u32 m0, s37, 22656
    v_mfma_f32_32x32x16_bf16 v[24:39], v[128:131], v[120:123], v[24:39]
    buffer_load_dwordx4 v11, s[16:19], s47 offen lds
    v_mfma_f32_32x32x16_bf16 v[40:55], v[128:131], v[124:127], v[40:55]
    s_add_u32 m0, s38, 22656
    v_mfma_f32_32x32x16_bf16 v[56:71], v[132:135], v[120:123], v[56:71]
    buffer_load_dwordx4 v12, s[16:19], s47 offen lds
    v_mfma_f32_32x32x16_bf16 v[72:87], v[132:135], v[124:127], v[72:87]
    s_add_u32 m0, s39, 22656
    s_nop 0
    buffer_load_dwordx4 v13, s[24:27], s47 offen lds
    ds_read_b32 v22, v20 offset:0
    s_add_u32 s47, s47, 88064
    s_setprio 2
    s_waitcnt lgkmcnt(0)
    v_readfirstlane_b32 s6, v22
    s_setprio 0
    s_cmp_ge_u32 s6, s50
    s_cbranch_scc1 G1_ok_19_L
LW_20_L:
    ds_read_b32 v22, v20 offset:0
    s_waitcnt lgkmcnt(0)
    v_readfirstlane_b32 s6, v22
    s_cmp_ge_u32 s6, s50
    s_cbranch_scc1 LWd_21_L
    s_sleep 2
    s_sub_u32 s98, s98, 1
    s_cbranch_scc0 LW_20_L
LWd_21_L:
G1_ok_19_L:
    ds_read_b128 v[120:123], v16 offset:8192
    ds_read_b128 v[124:127], v16 offset:12288
    ds_read_b64_tr_b16 v[128:129], v19 offset:22656
    ds_read_b64_tr_b16 v[130:131], v19 offset:24064
    ds_read_b64_tr_b16 v[132:133], v19 offset:22784
    ds_read_b64_tr_b16 v[134:135], v19 offset:24192
    s_add_u32 m0, s34, 45312
    v_mfma_f32_32x32x16_bf16 v[24:39], v[148:151], v[140:143], v[24:39]
    buffer_load_dwordx4 v8, s[12:15], s47 offen lds
    v_mfma_f32_32x32x16_bf16 v[40:55], v[148:151], v[144:147], v[40:55]
    s_add_u32 m0, s35, 45312
    v_mfma_f32_32x32x16_bf16 v[56:71], v[152:155], v[140:143], v[56:71]
    buffer_load_dwordx4 v9, s[12:15], s47 offen lds
    v_mfma_f32_32x32x16_bf16 v[72:87], v[152:155], v[144:147], v[72:87]
    s_add_u32 m0, s36, 45312
    s_nop 0
    buffer_load_dwordx4 v10, s[20:23], s47 offen lds
    ds_read_b128 v[140:143], v17 offset:8192
    ds_read_b128 v[144:147], v17 offset:12288
    ds_read_b64_tr_b16 v[148:149], v19 offset:28288
    ds_read_b64_tr_b16 v[150:151], v19 offset:29696
    ds_read_b64_tr_b16 v[152:153], v19 offset:28416
    ds_read_b64_tr_b16 v[154:155], v19 offset:29824
    s_waitcnt vmcnt(9)
    ds_add_u32 v5, v21
    s_add_u32 s50, s50, 4
    s_waitcnt lgkmcnt(7)
    s_add_u32 m0, s37, 45312
    v_mfma_f32_32x32x16_bf16 v[24:39], v[128:131], v[120:123], v[24:39]
    buffer_load_dwordx4 v11, s[16:19], s47 offen lds
    v_mfma_f32_32x32x16_bf16 v[40:55], v[128:131], v[124:127], v[40:55]
    s_add_u32 m0, s38, 45312
    v_mfma_f32_32x32x16_bf16 v[56:71], v[132:135], v[120:123], v[56:71]
    buffer_load_dwordx4 v12, s[16:19], s47 offen lds
    v_mfma_f32_32x32x16_bf16 v[72:87], v[132:135], v[124:127], v[72:87]
    s_add_u32 m0, s39, 45312
    s_nop 0
    buffer_load_dwordx4 v13, s[24:27], s47 offen lds
    ds_read_b32 v22, v20 offset:0
    s_add_u32 s47, s47, 88064
    s_setprio 2
    s_waitcnt lgkmcnt(0)
    v_readfirstlane_b32 s6, v22
    v_add_u32 v14, 16384, v14
    v_add_u32 v15, 16384, v15
    v_add_u32 v16, 16384, v16
    v_add_u32 v17, 16384, v17
    s_setprio 0
    s_cmp_ge_u32 s6, s50
    s_cbranch_scc1 G1_ok_22_L
LW_23_L:
    ds_read_b32 v22, v20 offset:0
    s_waitcnt lgkmcnt(0)
    v_readfirstlane_b32 s6, v22
    s_cmp_ge_u32 s6, s50
    s_cbranch_scc1 LWd_24_L
    s_sleep 2
    s_sub_u32 s98, s98, 1
    s_cbranch_scc0 LW_23_L
LWd_24_L:
G1_ok_22_L:
    s_sub_u32 s51, s51, 1
    s_cmp_lg_u32 s51, 0
    s_cbranch_scc1 G1_loop_L
    buffer_load_dword v3, v4, s[8:11], s40 offen offset:384
    ds_read_b128 v[120:123], v14 offset:0
    ds_read_b128 v[124:127], v14 offset:4096
    ds_read_b64_tr_b16 v[128:129], v18 offset:0
    ds_read_b64_tr_b16 v[130:131], v18 offset:1408
    ds_read_b64_tr_b16 v[132:133], v18 offset:128
    ds_read_b64_tr_b16 v[134:135], v18 offset:1536
    s_add_u32 m0, s34, 67968
    v_mfma_f32_32x32x16_bf16 v[24:39], v[148:151], v[140:143], v[24:39]
    buffer_load_dwordx4 v8, s[12:15], s47 offen lds
    v_mfma_f32_32x32x16_bf16 v[40:55], v[148:151], v[144:147], v[40:55]
    s_add_u32 m0, s35, 67968
    v_mfma_f32_32x32x16_bf16 v[56:71], v[152:155], v[140:143], v[56:71]
    buffer_load_dwordx4 v9, s[12:15], s47 offen lds
    v_mfma_f32_32x32x16_bf16 v[72:87], v[152:155], v[144:147], v[72:87]
    s_add_u32 m0, s36, 67968
    s_nop 0
    buffer_load_dwordx4 v10, s[20:23], s47 offen lds
    ds_read_b128 v[140:143], v15 offset:0
    ds_read_b128 v[144:147], v15 offset:4096
    ds_read_b64_tr_b16 v[148:149], v18 offset:5632
    ds_read_b64_tr_b16 v[150:151], v18 offset:7040
    ds_read_b64_tr_b16 v[152:153], v18 offset:5760
    ds_read_b64_tr_b16 v[154:155], v18 offset:7168
    s_waitcnt vmcnt(9)
    ds_add_u32 v5, v21
    s_add_u32 s50, s50, 4
    s_waitcnt lgkmcnt(7)
    s_add_u32 m0, s37, 67968
    v_mfma_f32_32x32x16_bf16 v[24:39], v[128:131], v[120:123], v[24:39]
    buffer_load_dwordx4 v11, s[16:19], s47 offen lds
    v_mfma_f32_32x32x16_bf16 v[40:55], v[128:131], v[124:127], v[40:55]
    s_add_u32 m0, s38, 67968
    v_mfma_f32_32x32x16_bf16 v[56:71], v[132:135], v[120:123], v[56:71]
    buffer_load_dwordx4 v12, s[16:19], s47 offen lds
    v_mfma_f32_32x32x16_bf16 v[72:87], v[132:135], v[124:127], v[72:87]
    s_add_u32 m0, s39, 67968
    s_nop 0
    buffer_load_dwordx4 v13, s[24:27], s47 offen lds
    ds_read_b32 v22, v20 offset:0
    s_add_u32 s47, s47, 88064
    s_setprio 2
    s_waitcnt lgkmcnt(0)
    v_readfirstlane_b32 s6, v22
    s_setprio 0
    s_cmp_ge_u32 s6, s50
    s_cbranch_scc1 G1_ok_25_L
LW_26_L:
    ds_read_b32 v22, v20 offset:0
    s_waitcnt lgkmcnt(0)
    v_readfirstlane_b32 s6, v22
    s_cmp_ge_u32 s6, s50
    s_cbranch_scc1 LWd_27_L
    s_sleep 2
    s_sub_u32 s98, s98, 1
    s_cbranch_scc0 LW_26_L
LWd_27_L:
G1_ok_25_L:
    s_mov_b32 s8, s64
    s_mov_b32 s9, s65
    s_mov_b32 s10, 524288
    s_mov_b32 s11, 0x20000
    ds_read_b128 v[120:123], v16 offset:0
    ds_read_b128 v[124:127], v16 offset:4096
    ds_read_b64_tr_b16 v[128:129], v18 offset:22656
    ds_read_b64_tr_b16 v[130:131], v18 offset:24064
    ds_read_b64_tr_b16 v[132:133], v18 offset:22784
    ds_read_b64_tr_b16 v[134:135], v18 offset:24192
    s_add_u32 m0, s7, 65536
    s_mov_b32 s6, 0
    v_mfma_f32_32x32x16_bf16 v[24:39], v[148:151], v[140:143], v[24:39]
    buffer_load_dwordx4 v7, s[8:11], s6 offen lds
    v_mfma_f32_32x32x16_bf16 v[40:55], v[148:151], v[144:147], v[40:55]
    s_add_u32 m0, s7, 69632
    s_mov_b32 s6, 32768
    v_mfma_f32_32x32x16_bf16 v[56:71], v[152:155], v[140:143], v[56:71]
    buffer_load_dwordx4 v7, s[8:11], s6 offen lds
    v_mfma_f32_32x32x16_bf16 v[72:87], v[152:155], v[144:147], v[72:87]
    s_add_u32 m0, s7, 73728
    s_mov_b32 s6, 65536
    buffer_load_dwordx4 v7, s[8:11], s6 offen lds
    ds_read_b128 v[140:143], v17 offset:0
    ds_read_b128 v[144:147], v17 offset:4096
    ds_read_b64_tr_b16 v[148:149], v18 offset:28288
    ds_read_b64_tr_b16 v[150:151], v18 offset:29696
    ds_read_b64_tr_b16 v[152:153], v18 offset:28416
    ds_read_b64_tr_b16 v[154:155], v18 offset:29824
    s_waitcnt vmcnt(9)
    ds_add_u32 v5, v21
    s_add_u32 s50, s50, 4
    s_waitcnt lgkmcnt(7)
    s_add_u32 m0, s7, 77824
    s_mov_b32 s6, 98304
    v_mfma_f32_32x32x16_bf16 v[24:39], v[128:131], v[120:123], v[24:39]
    buffer_load_dwordx4 v7, s[8:11], s6 offen lds
    v_mfma_f32_32x32x16_bf16 v[40:55], v[128:131], v[124:127], v[40:55]
    s_add_u32 m0, s7, 81920
    s_mov_b32 s6, 131072
    v_mfma_f32_32x32x16_bf16 v[56:71], v[132:135], v[120:123], v[56:71]
    buffer_load_dwordx4 v7, s[8:11], s6 offen lds
    v_mfma_f32_32x32x16_bf16 v[72:87], v[132:135], v[124:127], v[72:87]
    ds_read_b32 v22, v20 offset:0
    s_add_u32 s47, s47, 88064
    s_setprio 2
    s_waitcnt lgkmcnt(0)
    v_readfirstlane_b32 s6, v22
    s_setprio 0
    s_cmp_ge_u32 s6, s50
    s_cbranch_scc1 G1_ok_28_L
LW_29_L:
    ds_read_b32 v22, v20 offset:0
    s_waitcnt lgkmcnt(0)
    v_readfirstlane_b32 s6, v22
    s_cmp_ge_u32 s6, s50
    s_cbranch_scc1 LWd_30_L
    s_sleep 2
    s_sub_u32 s98, s98, 1
    s_cbranch_scc0 LW_29_L
LWd_30_L:
G1_ok_28_L:
    ds_read_b128 v[120:123], v14 offset:8192
    ds_read_b128 v[124:127], v14 offset:12288
    ds_read_b64_tr_b16 v[128:129], v19 offset:0
    ds_read_b64_tr_b16 v[130:131], v19 offset:1408
    ds_read_b64_tr_b16 v[132:133], v19 offset:128
    ds_read_b64_tr_b16 v[134:135], v19 offset:1536
    s_add_u32 m0, s7, 86016
    s_mov_b32 s6, 163840
    v_mfma_f32_32x32x16_bf16 v[24:39], v[148:151], v[140:143], v[24:39]
    buffer_load_dwordx4 v7, s[8:11], s6 offen lds
    v_mfma_f32_32x32x16_bf16 v[40:55], v[148:151], v[144:147], v[40:55]
    s_add_u32 m0, s7, 90112
    s_mov_b32 s6, 196608
    v_mfma_f32_32x32x16_bf16 v[56:71], v[152:155], v[140:143], v[56:71]
    buffer_load_dwordx4 v7, s[8:11], s6 offen lds
    v_mfma_f32_32x32x16_bf16 v[72:87], v[152:155], v[144:147], v[72:87]
    s_add_u32 m0, s7, 94208
    s_mov_b32 s6, 229376
    buffer_load_dwordx4 v7, s[8:11], s6 offen lds
    ds_read_b128 v[140:143], v15 offset:8192
    ds_read_b128 v[144:147], v15 offset:12288
    ds_read_b64_tr_b16 v[148:149], v19 offset:5632
    ds_read_b64_tr_b16 v[150:151], v19 offset:7040
    ds_read_b64_tr_b16 v[152:153], v19 offset:5760
    ds_read_b64_tr_b16 v[154:155], v19 offset:7168
    s_waitcnt vmcnt(8)
    ds_add_u32 v5, v21
    s_add_u32 s50, s50, 4
    s_waitcnt lgkmcnt(7)
    s_add_u32 m0, s7, 98304
    s_mov_b32 s6, 262144
    v_mfma_f32_32x32x16_bf16 v[24:39], v[128:131], v[120:123], v[24:39]
    buffer_load_dwordx4 v7, s[8:11], s6 offen lds
    v_mfma_f32_32x32x16_bf16 v[40:55], v[128:131], v[124:127], v[40:55]
    s_add_u32 m0, s7, 102400
    s_mov_b32 s6, 294912
    v_mfma_f32_32x32x16_bf16 v[56:71], v[132:135], v[120:123], v[56:71]
    buffer_load_dwordx4 v7, s[8:11], s6 offen lds
    v_mfma_f32_32x32x16_bf16 v[72:87], v[132:135], v[124:127], v[72:87]
    s_add_u32 m0, s7, 106496
    s_mov_b32 s6, 327680
    buffer_load_dwordx4 v7, s[8:11], s6 offen lds
    ds_read_b32 v22, v20 offset:0
    s_add_u32 s47, s47, 88064
    s_setprio 2
    s_waitcnt lgkmcnt(0)
    v_readfirstlane_b32 s6, v22
    s_setprio 0
    s_cmp_ge_u32 s6, s50
    s_cbranch_scc1 G1_ok_31_L
LW_32_L:
    ds_read_b32 v22, v20 offset:0
    s_waitcnt lgkmcnt(0)
    v_readfirstlane_b32 s6, v22
    s_cmp_ge_u32 s6, s50
    s_cbranch_scc1 LWd_33_L
    s_sleep 2
    s_sub_u32 s98, s98, 1
    s_cbranch_scc0 LW_32_L
LWd_33_L:
G1_ok_31_L:
    ds_read_b128 v[120:123], v16 offset:8192
    ds_read_b128 v[124:127], v16 offset:12288
    ds_read_b64_tr_b16 v[128:129], v19 offset:22656
    ds_read_b64_tr_b16 v[130:131], v19 offset:24064
    ds_read_b64_tr_b16 v[132:133], v19 offset:22784
    ds_read_b64_tr_b16 v[134:135], v19 offset:24192
    s_add_u32 m0, s7, 110592
    s_mov_b32 s6, 360448
    v_mfma_f32_32x32x16_bf16 v[24:39], v[148:151], v[140:143], v[24:39]
    buffer_load_dwordx4 v7, s[8:11], s6 offen lds
    v_mfma_f32_32x32x16_bf16 v[40:55], v[148:151], v[144:147], v[40:55]
    s_add_u32 m0, s7, 114688
    s_mov_b32 s6, 393216
    v_mfma_f32_32x32x16_bf16 v[56:71], v[152:155], v[140:143], v[56:71]
    buffer_load_dwordx4 v7, s[8:11], s6 offen lds
    v_mfma_f32_32x32x16_bf16 v[72:87], v[152:155], v[144:147], v[72:87]
    s_add_u32 m0, s7, 118784
    s_mov_b32 s6, 425984
    buffer_load_dwordx4 v7, s[8:11], s6 offen lds
    ds_read_b128 v[140:143], v17 offset:8192
    ds_read_b128 v[144:147], v17 offset:12288
    ds_read_b64_tr_b16 v[148:149], v19 offset:28288
    ds_read_b64_tr_b16 v[150:151], v19 offset:29696
    ds_read_b64_tr_b16 v[152:153], v19 offset:28416
    ds_read_b64_tr_b16 v[154:155], v19 offset:29824
    ds_add_u32 v5, v21
    s_add_u32 s50, s50, 4
    s_waitcnt lgkmcnt(7)
    s_add_u32 m0, s7, 122880
    s_mov_b32 s6, 458752
    v_mfma_f32_32x32x16_bf16 v[24:39], v[128:131], v[120:123], v[24:39]
    buffer_load_dwordx4 v7, s[8:11], s6 offen lds
    v_mfma_f32_32x32x16_bf16 v[40:55], v[128:131], v[124:127], v[40:55]
    s_add_u32 m0, s7, 126976
    s_mov_b32 s6, 491520
    v_mfma_f32_32x32x16_bf16 v[56:71], v[132:135], v[120:123], v[56:71]
    buffer_load_dwordx4 v7, s[8:11], s6 offen lds
    v_mfma_f32_32x32x16_bf16 v[72:87], v[132:135], v[124:127], v[72:87]
    ds_read_b32 v22, v20 offset:0
    s_add_u32 s47, s47, 88064
    s_setprio 2
    s_waitcnt lgkmcnt(0)
    v_readfirstlane_b32 s6, v22
    s_setprio 0
    s_cmp_ge_u32 s6, s50
    s_cbranch_scc1 G1_ok_34_L
LW_35_L:
    ds_read_b32 v22, v20 offset:0
    s_waitcnt lgkmcnt(0)
    v_readfirstlane_b32 s6, v22
    s_cmp_ge_u32 s6, s50
    s_cbranch_scc1 LWd_36_L
    s_sleep 2
    s_sub_u32 s98, s98, 1
    s_cbranch_scc0 LW_35_L
LWd_36_L:
G1_ok_34_L:
    v_mfma_f32_32x32x16_bf16 v[24:39], v[148:151], v[140:143], v[24:39]
    v_mfma_f32_32x32x16_bf16 v[40:55], v[148:151], v[144:147], v[40:55]
    v_mfma_f32_32x32x16_bf16 v[56:71], v[152:155], v[140:143], v[56:71]
    v_mfma_f32_32x32x16_bf16 v[72:87], v[152:155], v[144:147], v[72:87]
    s_branch G1_done
M_A:
    v_mov_b32 v200, 160256
    v_mov_b32 v201, 1
    v_lshlrev_b32 v7, 2, v1
    s_and_b32 s41, s3, 1
    s_lshr_b32 s42, s3, 1
    s_lshl_b32 s32, s3, 12
    v_lshrrev_b32 v2, 3, v1
    v_and_b32 v3, 7, v1
    v_bfe_u32 v6, v2, 1, 1
    v_lshlrev_b32 v6, 2, v6
    v_xor_b32 v6, v6, v3
    v_lshlrev_b32 v6, 4, v6
    v_lshl_add_u32 v6, v2, 10, v6
    s_lshl_b32 s6, s5, 7
    s_lshl_b32 s34, s3, 15
    s_add_u32 s6, s6, s34
    v_add_u32 v15, s6, v6
    s_waitcnt lgkmcnt(0)
    s_cmp_lg_u32 s3, 1
    s_cbranch_scc1 A_notouch
    s_cmp_lg_u32 s2, 0
    s_cbranch_scc1 A_notouch
    s_memrealtime s[34:35]
    s_mov_b32 s8, s78
    s_mov_b32 s9, s79
    s_mov_b32 s10, 256
    s_mov_b32 s11, 0x20000
    s_waitcnt lgkmcnt(0)
    s_or_b32 s34, s34, 1
    v_mov_b32 v2, s34
    v_mov_b32 v3, 0
    s_mov_b64 exec, 1
    buffer_store_dword v2, v3, s[8:11], 0 offen sc1
    s_mov_b64 exec, -1
A_notouch:
    s_mov_b32 s8, s58
    s_mov_b32 s9, s59
    s_mov_b32 s10, 524288
    s_mov_b32 s11, 0x20000
    s_barrier
    s_cmp_lt_u32 s3, 2
    s_cbranch_scc1 A_nowqt
    s_lshr_b32 s6, s2, 6
    s_lshl_b32 s6, s6, 1
    s_add_u32 s6, s6, s41
    s_lshl_b32 s6, s6, 16
    s_lshl_b32 s34, s5, 7
    s_add_u32 s6, s6, s34
    v_lshlrev_b32 v2, 10, v1
    buffer_load_dword v222, v2, s[8:11], s6 offen
A_nowqt:
    s_add_u32 m0, s32, 88192
    s_mov_b32 s6, 0
    buffer_load_dwordx4 v15, s[8:11], s6 offen lds
    s_add_u32 m0, s32, 89216
    s_mov_b32 s6, 8192
    buffer_load_dwordx4 v15, s[8:11], s6 offen lds
    s_add_u32 m0, s32, 90240
    s_mov_b32 s6, 16384
    buffer_load_dwordx4 v15, s[8:11], s6 offen lds
    s_add_u32 m0, s32, 91264
    s_mov_b32 s6, 24576
    buffer_load_dwordx4 v15, s[8:11], s6 offen lds
    s_add_u32 m0, s32, 104576
    s_mov_b32 s6, 131072
    buffer_load_dwordx4 v15, s[8:11], s6 offen lds
    s_add_u32 m0, s32, 105600
    s_mov_b32 s6, 139264
    buffer_load_dwordx4 v15, s[8:11], s6 offen lds
    s_add_u32 m0, s32, 106624
    s_mov_b32 s6, 147456
    buffer_load_dwordx4 v15, s[8:11], s6 offen lds
    s_add_u32 m0, s32, 107648
    s_mov_b32 s6, 155648
    buffer_load_dwordx4 v15, s[8:11], s6 offen lds
    v_and_b32 v2, 31, v1
    v_lshrrev_b32 v3, 5, v1
    v_bfe_u32 v5, v2, 1, 3
    s_lshl_b32 s6, s41, 12
    v_lshl_add_u32 v2, v2, 7, s6
    v_or_b32 v6, 0, v3
    v_xor_b32 v6, v6, v5
    v_lshl_add_u32 v16, v6, 4, v2
    v_or_b32 v6, 2, v3
    v_xor_b32 v6, v6, v5
    v_lshl_add_u32 v17, v6, 4, v2
    v_or_b32 v6, 4, v3
    v_xor_b32 v6, v6, v5
    v_lshl_add_u32 v18, v6, 4, v2
    v_or_b32 v6, 6, v3
    v_xor_b32 v6, v6, v5
    v_lshl_add_u32 v19, v6, 4, v2
    v_bfe_u32 v2, v1, 2, 2
    v_lshl_add_u32 v3, v3, 3, v2
    v_lshlrev_b32 v3, 7, v3
    v_bfe_u32 v2, v1, 3, 1
    v_xor_b32 v2, s42, v2
    v_lshl_add_u32 v3, v2, 6, v3
    v_bfe_u32 v2, v1, 4, 1
    v_lshl_add_u32 v3, v2, 5, v3
    v_and_b32 v2, 3, v1
    v_lshl_add_u32 v3, v2, 3, v3
    v_add_u32 v20, 88192, v3
LW_48:
    ds_read_b32 v209, v200 offset:56
    s_waitcnt lgkmcnt(0)
    v_readfirstlane_b32 s6, v209
    s_cmp_ge_u32 s6, 3
    s_cbranch_scc1 LWd_49
    s_sleep 1
    s_sub_u32 s98, s98, 1
    s_cbranch_scc0 LW_48
LWd_49:
    s_add_u32 m0, s32, 120960
    s_mov_b32 s6, 262144
    buffer_load_dwordx4 v15, s[8:11], s6 offen lds
    s_add_u32 m0, s32, 121984
    s_mov_b32 s6, 270336
    buffer_load_dwordx4 v15, s[8:11], s6 offen lds
    s_add_u32 m0, s32, 123008
    s_mov_b32 s6, 278528
    buffer_load_dwordx4 v15, s[8:11], s6 offen lds
    s_add_u32 m0, s32, 124032
    s_mov_b32 s6, 286720
    buffer_load_dwordx4 v15, s[8:11], s6 offen lds
    s_add_u32 m0, s32, 137344
    s_mov_b32 s6, 393216
    buffer_load_dwordx4 v15, s[8:11], s6 offen lds
    s_add_u32 m0, s32, 138368
    s_mov_b32 s6, 401408
    buffer_load_dwordx4 v15, s[8:11], s6 offen lds
    s_add_u32 m0, s32, 139392
    s_mov_b32 s6, 409600
    buffer_load_dwordx4 v15, s[8:11], s6 offen lds
    s_add_u32 m0, s32, 140416
    s_mov_b32 s6, 417792
    buffer_load_dwordx4 v15, s[8:11], s6 offen lds
    s_cmp_eq_u32 s3, 1
    s_cselect_b32 s16, s70, s68
    s_cselect_b32 s17, s71, s69
    s_cmp_eq_u32 s3, 2
    s_cselect_b32 s16, s72, s16
    s_cselect_b32 s17, s73, s17
    s_cmp_eq_u32 s3, 3
    s_cselect_b32 s16, s64, s16
    s_cselect_b32 s17, s65, s17
    s_cselect_b32 s35, 16, 43
    s_mul_i32 s34, s2, s35
    s_lshl_b32 s34, s34, 7
    s_lshl_b32 s35, s35, 7
    s_add_u32 s18, s34, s35
    s_cmp_ge_u32 s3, 2
    s_cselect_b32 s18, 0, s18
    s_mov_b32 s19, 0x20000
    v_lshlrev_b32 v223, 7, v1
    buffer_load_dword v222, v223, s[16:19], s34 offen
    v_mov_b64 v[24:25], 0
    v_mov_b64 v[26:27], 0
    v_mov_b64 v[28:29], 0
    v_mov_b64 v[30:31], 0
    v_mov_b64 v[32:33], 0
    v_mov_b64 v[34:35], 0
    v_mov_b64 v[36:37], 0
    v_mov_b64 v[38:39], 0
    v_mov_b64 v[40:41], 0
    v_mov_b64 v[42:43], 0
    v_mov_b64 v[44:45], 0
    v_mov_b64 v[46:47], 0
    v_mov_b64 v[48:49], 0
    v_mov_b64 v[50:51], 0
    v_mov_b64 v[52:53], 0
    v_mov_b64 v[54:55], 0
    v_mov_b64 v[56:57], 0
    v_mov_b64 v[58:59], 0
    v_mov_b64 v[60:61], 0
    v_mov_b64 v[62:63], 0
    v_mov_b64 v[64:65], 0
    v_mov_b64 v[66:67], 0
    v_mov_b64 v[68:69], 0
    v_mov_b64 v[70:71], 0
    v_mov_b64 v[72:73], 0
    v_mov_b64 v[74:75], 0
    v_mov_b64 v[76:77], 0
    v_mov_b64 v[78:79], 0
    v_mov_b64 v[80:81], 0
    v_mov_b64 v[82:83], 0
    v_mov_b64 v[84:85], 0
    v_mov_b64 v[86:87], 0
    v_lshrrev_b32 v2, 5, v1
    v_mul_u32_u24 v2, 288, v2
    v_and_b32 v3, 31, v1
    v_min_u32 v5, 16, v3
    v_lshl_add_u32 v5, v5, 4, v2
    v_and_b32 v3, 27, v3
    v_cmp_lt_u32 vcc, 16, v3
    v_mov_b32 v3, 0x40000000
    v_mov_b32 v6, 0xdddd
    v_cndmask_b32 v5, v5, v3, vcc
    v_lshrrev_b32 v2, 1, v1
    v_and_b32 v3, 1, v1
    v_lshlrev_b32 v3, 4, v3
    v_lshl_add_u32 v208, v2, 7, v3
    s_lshl_b32 s6, s41, 11
    s_add_u32 s6, s6, 156160
    v_add_u32 v210, s6, v4
    s_lshl_b32 s6, s3, 2
    v_add_u32 v202, s6, v200
    v_xor_b32 v203, 8, v202
    s_lshl_b32 s6, s41, 2
    v_add_u32 v204, s6, v200
    v_mov_b32 v205, 2
    s_mul_i32 s6, s3, 4608
    s_add_u32 s6, s6, 131072
    v_add_u32 v211, s6, v4
    v_add_u32 v216, s6, v7
    s_xor_b32 s6, s3, 2
    s_mul_i32 s6, s6, 4608
    s_add_u32 s6, s6, 131072
    v_add_u32 v217, s6, v4
    v_add_u32 v218, s6, v7
    s_lshl_b32 s7, s4, 1
    s_add_u32 s7, s7, s41
    s_lshl_b32 s7, s7, 5
    s_lshl_b32 s6, s5, 2
    s_add_u32 s7, s7, s6
    s_lshl_b32 s6, s42, 1
    s_add_u32 s7, s7, s6
    s_lshl_b32 s7, s7, 10
    s_mov_b32 s44, 0
    s_mov_b32 s50, 0x55555555
    s_mov_b32 s51, 3
    s_lshl_b32 s48, s42, 11
    s_lshl_b32 s49, s42, 8
    s_mul_i32 s6, s42, 69632
    s_add_u32 s6, s6, 4194304
    s_add_u32 s12, s80, s6
    s_addc_u32 s13, s81, 0
    s_mov_b32 s14, 69632
    s_mov_b32 s15, 0x20000
    s_add_u32 s20, s80, 4399104
    s_addc_u32 s21, s81, 0
    s_mov_b32 s22, 512
    s_mov_b32 s23, 0x20000
    s_add_u32 s28, s80, 4423680
    s_addc_u32 s29, s81, 0
    s_mov_b32 s30, 139264
    s_mov_b32 s31, 0x20000
    s_mov_b32 s24, s76
    s_mov_b32 s25, s77
    s_mov_b32 s26, 2097152
    s_mov_b32 s27, 0x20000
    s_and_b32 s61, s3, 1
    s_lshr_b32 s56, s3, 1
    s_and_b32 s6, s5, 1
    s_lshl_b32 s6, s6, 1
    s_xor_b32 s56, s56, s6
    v_bfe_u32 v2, v1, 2, 2
    v_lshrrev_b32 v3, 5, v1
    v_lshl_add_u32 v3, v3, 2, v2
    v_lshlrev_b32 v3, 7, v3
    v_bfe_u32 v2, v1, 3, 1
    v_lshl_add_u32 v3, v2, 6, v3
    v_bfe_u32 v2, v1, 4, 1
    v_lshl_add_u32 v3, v2, 5, v3
    v_and_b32 v2, 3, v1
    v_lshl_add_u32 v233, v2, 3, v3
    s_lshl_b32 s6, s56, 14
    s_add_u32 s6, s6, 65536
    v_add_u32 v232, s6, v233
    v_lshrrev_b32 v3, 1, v1
    v_and_b32 v2, 1, v1
    v_lshlrev_b32 v2, 3, v2
    v_lshl_add_u32 v241, v3, 7, v2
    s_lshl_b32 s6, s4, 2
    s_add_u32 s6, s6, s56
    s_lshl_b32 s6, s6, 6
    s_add_u32 s6, s6, s61
    s_lshl_b32 s6, s6, 2
    s_add_u32 s60, s6, 0x2000
    v_lshlrev_b32 v242, 4, v1
    s_lshl_b32 s6, s4, 1
    s_add_u32 s6, s6, s61
    s_lshl_b32 s59, s6, 15
    s_lshl_b32 s6, s56, 13
    s_add_u32 s57, s59, s6
    s_add_u32 s58, s57, 4096
    v_lshrrev_b32 v2, 3, v1
    v_and_b32 v3, 7, v1
    v_lshlrev_b32 v239, 10, v2
    v_lshl_add_u32 v239, v3, 4, v239
    v_lshlrev_b32 v3, 1, v3
    v_xor_b32 v3, v3, v2
    v_lshlrev_b32 v3, 4, v3
    v_lshl_add_u32 v3, v2, 8, v3
    s_lshl_b32 s6, s3, 11
    v_add_u32 v238, s6, v3
    s_lshl_b32 s6, s4, 3
    s_add_u32 s6, s6, s3
    s_lshl_b32 s59, s6, 13
    s_lshl_b32 s6, s5, 7
    s_add_u32 s59, s59, s6
    s_lshl_b32 s6, s3, 13
    s_add_u32 s6, s6, 65536
    v_and_b32 v2, 7, v1
    v_lshrrev_b32 v3, 5, v1
    v_xor_b32 v3, v3, v2
    v_and_b32 v2, 31, v1
    v_lshlrev_b32 v3, 4, v3
    v_lshl_add_u32 v3, v2, 8, v3
    v_add_u32 v234, s6, v3
    v_xor_b32 v235, 32, v234
    v_xor_b32 v236, 64, v234
    v_xor_b32 v237, 96, v234
    s_lshl_b32 s6, s61, 7
    s_add_u32 s6, s6, 160384
    v_lshl_add_u32 v240, v2, 2, s6
    v_xor_b32 v233, 64, v232
    s_waitcnt vmcnt(9)
    s_mov_b64 exec, 1
    ds_add_u32 v200, v201 offset:4
    s_mov_b64 exec, -1
LW_50:
    ds_read_b32 v209, v200 offset:60
    s_waitcnt lgkmcnt(0)
    v_readfirstlane_b32 s6, v209
    s_cmp_ge_u32 s6, 4
    s_cbranch_scc1 LWd_51
    s_sleep 1
    s_sub_u32 s98, s98, 1
    s_cbranch_scc0 LW_50
LWd_51:
LW_52:
    ds_read_b32 v209, v200 offset:4
    s_waitcnt lgkmcnt(0)
    v_readfirstlane_b32 s6, v209
    s_cmp_ge_u32 s6, 4
    s_cbranch_scc1 LWd_53
    s_sleep 1
    s_sub_u32 s98, s98, 1
    s_cbranch_scc0 LW_52
LWd_53:
    ds_read_b128 v[104:107], v16 offset:0
    ds_read_b64_tr_b16 v[108:109], v20 offset:0
    ds_read_b64_tr_b16 v[110:111], v20 offset:512
    ds_read_b128 v[112:115], v17 offset:0
    ds_read_b64_tr_b16 v[116:117], v20 offset:2048
    ds_read_b64_tr_b16 v[118:119], v20 offset:2560
    ds_read_b128 v[120:123], v18 offset:0
    ds_read_b64_tr_b16 v[124:125], v20 offset:4096
    ds_read_b64_tr_b16 v[126:127], v20 offset:4608
    ds_read_b128 v[128:131], v19 offset:0
    ds_read_b64_tr_b16 v[132:133], v20 offset:6144
    ds_read_b64_tr_b16 v[134:135], v20 offset:6656
    ds_read_b128 v[136:139], v16 offset:8192
    ds_read_b64_tr_b16 v[140:141], v20 offset:8192
    ds_read_b64_tr_b16 v[142:143], v20 offset:8704
    s_waitcnt lgkmcnt(12)
    v_mfma_f32_32x32x16_bf16 v[88:103], v[108:111], v[104:107], 0
    ds_read_b128 v[144:147], v17 offset:8192
    ds_read_b64_tr_b16 v[148:149], v20 offset:10240
    ds_read_b64_tr_b16 v[150:151], v20 offset:10752
    s_waitcnt lgkmcnt(12)
    v_mfma_f32_32x32x16_bf16 v[88:103], v[116:119], v[112:115], v[88:103]
    ds_read_b128 v[104:107], v18 offset:8192
    ds_read_b64_tr_b16 v[108:109], v20 offset:12288
    ds_read_b64_tr_b16 v[110:111], v20 offset:12800
    s_waitcnt lgkmcnt(12)
    v_mfma_f32_32x32x16_bf16 v[88:103], v[124:127], v[120:123], v[88:103]
    ds_read_b128 v[112:115], v19 offset:8192
    ds_read_b64_tr_b16 v[116:117], v20 offset:14336
    ds_read_b64_tr_b16 v[118:119], v20 offset:14848
    s_waitcnt lgkmcnt(12)
    v_mfma_f32_32x32x16_bf16 v[88:103], v[132:135], v[128:131], v[88:103]
    ds_read_b128 v[120:123], v16 offset:16384
    ds_read_b64_tr_b16 v[124:125], v20 offset:16384
    ds_read_b64_tr_b16 v[126:127], v20 offset:16896
    s_waitcnt lgkmcnt(12)
    v_mfma_f32_32x32x16_bf16 v[88:103], v[140:143], v[136:139], v[88:103]
    ds_read_b128 v[128:131], v17 offset:16384
    ds_read_b64_tr_b16 v[132:133], v20 offset:18432
    ds_read_b64_tr_b16 v[134:135], v20 offset:18944
    s_waitcnt lgkmcnt(12)
    v_mfma_f32_32x32x16_bf16 v[88:103], v[148:151], v[144:147], v[88:103]
    ds_read_b128 v[136:139], v18 offset:16384
    ds_read_b64_tr_b16 v[140:141], v20 offset:20480
    ds_read_b64_tr_b16 v[142:143], v20 offset:20992
    s_waitcnt lgkmcnt(12)
    s_waitcnt vmcnt(1)
    s_mov_b64 exec, 1
    ds_add_u32 v200, v201 offset:84
    s_mov_b64 exec, -1
    v_mfma_f32_32x32x16_bf16 v[88:103], v[108:111], v[104:107], v[88:103]
    s_waitcnt lgkmcnt(10)
    ds_read_b128 v[144:147], v19 offset:16384
    ds_read_b64_tr_b16 v[148:149], v20 offset:22528
    ds_read_b64_tr_b16 v[150:151], v20 offset:23040
    v_mfma_f32_32x32x16_bf16 v[88:103], v[116:119], v[112:115], v[88:103]
    s_waitcnt lgkmcnt(10)
    ds_read_b128 v[104:107], v16 offset:24576
    ds_read_b64_tr_b16 v[108:109], v20 offset:24576
    ds_read_b64_tr_b16 v[110:111], v20 offset:25088
    v_mfma_f32_32x32x16_bf16 v[88:103], v[124:127], v[120:123], v[88:103]
    s_waitcnt lgkmcnt(10)
    ds_read_b128 v[112:115], v17 offset:24576
    ds_read_b64_tr_b16 v[116:117], v20 offset:26624
    ds_read_b64_tr_b16 v[118:119], v20 offset:27136
    v_mfma_f32_32x32x16_bf16 v[88:103], v[132:135], v[128:131], v[88:103]
    s_waitcnt lgkmcnt(10)
    ds_read_b128 v[120:123], v18 offset:24576
    ds_read_b64_tr_b16 v[124:125], v20 offset:28672
    ds_read_b64_tr_b16 v[126:127], v20 offset:29184
    v_mfma_f32_32x32x16_bf16 v[88:103], v[140:143], v[136:139], v[88:103]
    s_waitcnt lgkmcnt(12)
    ds_read_b128 v[128:131], v19 offset:24576
    ds_read_b64_tr_b16 v[132:133], v20 offset:30720
    ds_read_b64_tr_b16 v[134:135], v20 offset:31232
    s_waitcnt lgkmcnt(12)
    v_mfma_f32_32x32x16_bf16 v[88:103], v[148:151], v[144:147], v[88:103]
LW_54:
    ds_read_b32 v209, v200 offset:84
    s_waitcnt lgkmcnt(0)
    v_readfirstlane_b32 s6, v209
    s_cmp_ge_u32 s6, 4
    s_cbranch_scc1 LWd_55
    s_sleep 1
    s_sub_u32 s98, s98, 1
    s_cbranch_scc0 LW_54
LWd_55:
    ds_read_b128 v[136:139], v16 offset:32768
    ds_read_b64_tr_b16 v[140:141], v20 offset:32768
    ds_read_b64_tr_b16 v[142:143], v20 offset:33280
    v_mfma_f32_32x32x16_bf16 v[88:103], v[108:111], v[104:107], v[88:103]
    ds_read_b128 v[144:147], v17 offset:32768
    ds_read_b64_tr_b16 v[148:149], v20 offset:34816
    ds_read_b64_tr_b16 v[150:151], v20 offset:35328
    v_mfma_f32_32x32x16_bf16 v[88:103], v[116:119], v[112:115], v[88:103]
    ds_read_b128 v[104:107], v18 offset:32768
    ds_read_b64_tr_b16 v[108:109], v20 offset:36864
    ds_read_b64_tr_b16 v[110:111], v20 offset:37376
    v_mfma_f32_32x32x16_bf16 v[88:103], v[124:127], v[120:123], v[88:103]
    ds_read_b128 v[112:115], v19 offset:32768
    ds_read_b64_tr_b16 v[116:117], v20 offset:38912
    ds_read_b64_tr_b16 v[118:119], v20 offset:39424
    v_mfma_f32_32x32x16_bf16 v[88:103], v[132:135], v[128:131], v[88:103]
    ds_read_b128 v[120:123], v16 offset:40960
    ds_read_b64_tr_b16 v[124:125], v20 offset:40960
    ds_read_b64_tr_b16 v[126:127], v20 offset:41472
    s_waitcnt lgkmcnt(12)
    v_mfma_f32_32x32x16_bf16 v[88:103], v[140:143], v[136:139], v[88:103]
    ds_read_b128 v[128:131], v17 offset:40960
    ds_read_b64_tr_b16 v[132:133], v20 offset:43008
    ds_read_b64_tr_b16 v[134:135], v20 offset:43520
    s_waitcnt lgkmcnt(12)
    v_mfma_f32_32x32x16_bf16 v[88:103], v[148:151], v[144:147], v[88:103]
    ds_read_b128 v[136:139], v18 offset:40960
    ds_read_b64_tr_b16 v[140:141], v20 offset:45056
    ds_read_b64_tr_b16 v[142:143], v20 offset:45568
    s_waitcnt lgkmcnt(12)
    v_mfma_f32_32x32x16_bf16 v[88:103], v[108:111], v[104:107], v[88:103]
    ds_read_b128 v[144:147], v19 offset:40960
    ds_read_b64_tr_b16 v[148:149], v20 offset:47104
    ds_read_b64_tr_b16 v[150:151], v20 offset:47616
    s_waitcnt lgkmcnt(12)
    v_mfma_f32_32x32x16_bf16 v[88:103], v[116:119], v[112:115], v[88:103]
    ds_read_b128 v[104:107], v16 offset:49152
    ds_read_b64_tr_b16 v[108:109], v20 offset:49152
    ds_read_b64_tr_b16 v[110:111], v20 offset:49664
    s_waitcnt lgkmcnt(12)
    v_mfma_f32_32x32x16_bf16 v[88:103], v[124:127], v[120:123], v[88:103]
    ds_read_b128 v[112:115], v17 offset:49152
    ds_read_b64_tr_b16 v[116:117], v20 offset:51200
    ds_read_b64_tr_b16 v[118:119], v20 offset:51712
    s_waitcnt lgkmcnt(12)
    v_mfma_f32_32x32x16_bf16 v[88:103], v[132:135], v[128:131], v[88:103]
    ds_read_b128 v[120:123], v18 offset:49152
    ds_read_b64_tr_b16 v[124:125], v20 offset:53248
    ds_read_b64_tr_b16 v[126:127], v20 offset:53760
    s_waitcnt lgkmcnt(12)
    v_mfma_f32_32x32x16_bf16 v[88:103], v[140:143], v[136:139], v[88:103]
    ds_read_b128 v[128:131], v19 offset:49152
    ds_read_b64_tr_b16 v[132:133], v20 offset:55296
    ds_read_b64_tr_b16 v[134:135], v20 offset:55808
    s_waitcnt lgkmcnt(12)
    v_mfma_f32_32x32x16_bf16 v[88:103], v[148:151], v[144:147], v[88:103]
    ds_read_b128 v[136:139], v16 offset:57344
    ds_read_b64_tr_b16 v[140:141], v20 offset:57344
    ds_read_b64_tr_b16 v[142:143], v20 offset:57856
    s_waitcnt lgkmcnt(12)
    v_mfma_f32_32x32x16_bf16 v[88:103], v[108:111], v[104:107], v[88:103]
    ds_read_b128 v[144:147], v17 offset:57344
    ds_read_b64_tr_b16 v[148:149], v20 offset:59392
    ds_read_b64_tr_b16 v[150:151], v20 offset:59904
    s_waitcnt lgkmcnt(12)
    v_mfma_f32_32x32x16_bf16 v[88:103], v[116:119], v[112:115], v[88:103]
    ds_read_b128 v[104:107], v18 offset:57344
    ds_read_b64_tr_b16 v[108:109], v20 offset:61440
    ds_read_b64_tr_b16 v[110:111], v20 offset:61952
    s_waitcnt lgkmcnt(12)
    v_mfma_f32_32x32x16_bf16 v[88:103], v[124:127], v[120:123], v[88:103]
    ds_read_b128 v[112:115], v19 offset:57344
    ds_read_b64_tr_b16 v[116:117], v20 offset:63488
    ds_read_b64_tr_b16 v[118:119], v20 offset:64000
    s_waitcnt lgkmcnt(12)
    ds_read_b32 v209, v200 offset:8
    v_mfma_f32_32x32x16_bf16 v[88:103], v[132:135], v[128:131], v[88:103]
    s_waitcnt lgkmcnt(10)
    v_mfma_f32_32x32x16_bf16 v[88:103], v[140:143], v[136:139], v[88:103]
    s_waitcnt lgkmcnt(7)
    v_mfma_f32_32x32x16_bf16 v[88:103], v[148:151], v[144:147], v[88:103]
    s_waitcnt lgkmcnt(4)
    v_mfma_f32_32x32x16_bf16 v[88:103], v[108:111], v[104:107], v[88:103]
    s_waitcnt lgkmcnt(0)
    s_mov_b32 exec_hi, 0
    buffer_load_dwordx4 v[212:215], v208, s[28:31], s48 offen sc1
    s_mov_b32 exec_hi, -1
    v_mfma_f32_32x32x16_bf16 v[88:103], v[116:119], v[112:115], v[88:103]
    v_readfirstlane_b32 s46, v209
    s_mov_b32 s55, 0
    s_nop 8
    s_cmp_lg_u32 s42, 0
    v_cvt_pk_bf16_f32 v8, v88, v89
    v_cvt_pk_bf16_f32 v9, v90, v91
    v_cvt_pk_bf16_f32 v10, v92, v93
    v_cvt_pk_bf16_f32 v11, v94, v95
    v_cvt_pk_bf16_f32 v12, v96, v97
    v_cvt_pk_bf16_f32 v13, v98, v99
    v_cvt_pk_bf16_f32 v14, v100, v101
    v_cvt_pk_bf16_f32 v15, v102, v103
    s_cbranch_scc1 A_qx1
    ds_write_b128 v210, v[8:11]
    ds_write_b128 v210, v[12:15] offset:1024
    ds_write_b32 v204, v201 offset:48
LW_56:
    ds_read_b32 v3, v204 offset:48
    s_waitcnt lgkmcnt(0)
    v_readfirstlane_b32 s6, v3
    s_cmp_ge_u32 s6, 2
    s_cbranch_scc1 LWd_57
    s_sleep 1
    s_sub_u32 s98, s98, 1
    s_cbranch_scc0 LW_56
LWd_57:
    ds_read_b128 v[16:19], v210
    ds_read_b128 v[20:23], v210 offset:1024
    s_branch A_qx2
A_qx1:
LW_58:
    ds_read_b32 v3, v204 offset:48
    s_waitcnt lgkmcnt(0)
    v_readfirstlane_b32 s6, v3
    s_cmp_ge_u32 s6, 1
    s_cbranch_scc1 LWd_59
    s_sleep 1
    s_sub_u32 s98, s98, 1
    s_cbranch_scc0 LW_58
LWd_59:
    ds_read_b128 v[16:19], v210
    ds_read_b128 v[20:23], v210 offset:1024
    ds_write_b128 v210, v[8:11]
    ds_write_b128 v210, v[12:15] offset:1024
    ds_write_b32 v204, v205 offset:48
A_qx2:
    s_cmp_ge_u32 s55, 2
    s_cbranch_scc1 A_looked
    s_mov_b32 s47, 3
    s_cmp_lg_u32 s46, 0
    s_cbranch_scc1 A_relook
LW_60:
    ds_read_b32 v209, v200 offset:8
    s_waitcnt lgkmcnt(0)
    v_readfirstlane_b32 s46, v209
    s_cmp_ge_u32 s46, 1
    s_cbranch_scc1 LWd_61
    s_sleep 1
    s_sub_u32 s98, s98, 1
    s_cbranch_scc0 LW_60
LWd_61:
A_relook:
    s_mov_b32 exec_hi, 0
    s_waitcnt vmcnt(0)
    v_xor_b32 v212, s46, v212
    v_xor_b32 v213, s46, v213
    v_xor_b32 v214, s46, v214
    v_xor_b32 v215, s46, v215
    v_or_b32 v212, v212, v213
    v_or3_b32 v212, v212, v214, v215
    v_cmp_eq_u32 vcc, 0, v212
    buffer_load_dwordx4 v[212:215], v208, s[28:31], s48 offen sc1
    s_mov_b32 exec_hi, -1
    s_lshr_b32 s6, vcc_lo, 1
    s_and_b32 s44, s6, vcc_lo
    s_and_b32 s55, s44, s50
    s_bcnt1_i32_b32 s55, s55
    s_cmp_ge_u32 s55, 2
    s_cbranch_scc1 A_look_ok
    s_sub_u32 s47, s47, 1
    s_cbranch_scc0 A_relook
    s_branch A_late0
A_look_ok:
    s_and_b32 s6, s44, s50
    s_ff1_i32_b32 s6, s6
    s_bitset0_b32 s50, s6
    s_mul_i32 s43, s6, 2176
    buffer_load_dwordx4 v[152:155], v4, s[12:15], s43 offen offset:0 sc1
    buffer_load_dwordx4 v[156:159], v5, s[12:15], s43 offen offset:2048 sc1
    buffer_load_dwordx4 v[160:163], v5, s[12:15], s43 offen offset:2624 sc1
    buffer_load_dwordx4 v[164:167], v4, s[12:15], s43 offen offset:1024 sc1
    buffer_load_dwordx4 v[168:171], v5, s[12:15], s43 offen offset:3200 sc1
    buffer_load_dwordx4 v[172:175], v5, s[12:15], s43 offen offset:3776 sc1
    s_and_b32 s6, s44, s50
    s_ff1_i32_b32 s6, s6
    s_bitset0_b32 s50, s6
    s_mul_i32 s43, s6, 2176
    buffer_load_dwordx4 v[176:179], v4, s[12:15], s43 offen offset:0 sc1
    buffer_load_dwordx4 v[180:183], v5, s[12:15], s43 offen offset:2048 sc1
    buffer_load_dwordx4 v[184:187], v5, s[12:15], s43 offen offset:2624 sc1
A_late0:
    s_mov_b64 exec, 1
    ds_add_u32 v200, v201 offset:88
    s_mov_b64 exec, -1
A_looked:
    s_waitcnt lgkmcnt(0)
    v_dot2_f32_bf16 v88, v8, v8, 0
    v_dot2_f32_bf16 v89, v12, v12, 0
    v_dot2_f32_bf16 v90, v16, v16, 0
    v_dot2_f32_bf16 v91, v20, v20, 0
    v_dot2_f32_bf16 v88, v9, v9, v88
    v_dot2_f32_bf16 v89, v13, v13, v89
    v_dot2_f32_bf16 v90, v17, v17, v90
    v_dot2_f32_bf16 v91, v21, v21, v91
    v_dot2_f32_bf16 v88, v10, v10, v88
    v_dot2_f32_bf16 v89, v14, v14, v89
    v_dot2_f32_bf16 v90, v18, v18, v90
    v_dot2_f32_bf16 v91, v22, v22, v91
    v_dot2_f32_bf16 v88, v11, v11, v88
    v_dot2_f32_bf16 v89, v15, v15, v89
    v_dot2_f32_bf16 v90, v19, v19, v90
    v_dot2_f32_bf16 v91, v23, v23, v91
    s_nop 2
    v_max_u32 v2, v88, v89
    v_max3_u32 v2, v2, v90, v91
    v_mov_b32 v3, v2
    s_nop 1
    v_permlane32_swap_b32 v2, v3
    s_nop 1
    v_add_f32 v2, v2, v3
    v_mov_b32 v3, v2
    s_nop 1
    v_permlane16_swap_b32 v2, v3
    s_nop 1
    v_max_u32 v206, v2, v3
    s_nop 1
    v_max_u32_dpp v206, v206, v206 row_ror:8 row_mask:0xf bank_mask:0xf
    s_nop 1
    v_max_u32_dpp v206, v206, v206 row_ror:4 row_mask:0xf bank_mask:0xf
    s_nop 1
    v_max_u32_dpp v206, v206, v206 row_ror:2 row_mask:0xf bank_mask:0xf
    s_nop 1
    v_max_u32_dpp v206, v206, v206 row_ror:1 row_mask:0xf bank_mask:0xf
    s_cmp_ge_u32 s55, 2
    s_cbranch_scc1 A_started
LW_62:
    ds_read_b32 v209, v200 offset:8
    s_waitcnt lgkmcnt(0)
    v_readfirstlane_b32 s46, v209
    s_cmp_ge_u32 s46, 1
    s_cbranch_scc1 LWd_63
    s_sleep 1
    s_sub_u32 s98, s98, 1
    s_cbranch_scc0 LW_62
LWd_63:
    s_mov_b32 s44, 0
    s_and_b32 s6, s44, s50
    s_cbranch_scc0 A_rf_64
A_bk_65:
    s_ff1_i32_b32 s6, s6
    s_bitset0_b32 s50, s6
    s_mul_i32 s43, s6, 2176
A_b2_68:
    buffer_load_dwordx4 v[152:155], v4, s[12:15], s43 offen offset:0 sc1
    buffer_load_dwordx4 v[156:159], v5, s[12:15], s43 offen offset:2048 sc1
    buffer_load_dwordx4 v[160:163], v5, s[12:15], s43 offen offset:2624 sc1
    buffer_load_dwordx4 v[164:167], v4, s[12:15], s43 offen offset:1024 sc1
    buffer_load_dwordx4 v[168:171], v5, s[12:15], s43 offen offset:3200 sc1
    buffer_load_dwordx4 v[172:175], v5, s[12:15], s43 offen offset:3776 sc1
    s_and_b32 s6, s44, s50
    s_cbranch_scc0 A_rf_69
A_bk_70:
    s_ff1_i32_b32 s6, s6
    s_bitset0_b32 s50, s6
    s_mul_i32 s43, s6, 2176
A_b2_73:
    buffer_load_dwordx4 v[176:179], v4, s[12:15], s43 offen offset:0 sc1
    buffer_load_dwordx4 v[180:183], v5, s[12:15], s43 offen offset:2048 sc1
    buffer_load_dwordx4 v[184:187], v5, s[12:15], s43 offen offset:2624 sc1
A_started:
    s_setprio 1
    s_mov_b32 s52, 8
    s_mov_b32 s53, 1
    s_waitcnt vmcnt(6) lgkmcnt(0)
    v_mfma_f32_32x32x16_bf16 v[88:103], v[152:155], v[8:11], 0
    s_nop 10
    v_mfma_f32_32x32x16_bf16 v[104:119], v[152:155], v[12:15], 0
    v_exp_f32 v88, v88
    v_exp_f32 v89, v89
    v_exp_f32 v90, v90
    v_exp_f32 v91, v91
    v_exp_f32 v92, v92
    v_exp_f32 v93, v93
    v_exp_f32 v94, v94
    v_exp_f32 v95, v95
    v_exp_f32 v96, v96
    v_exp_f32 v97, v97
    v_exp_f32 v98, v98
    v_exp_f32 v99, v99
    v_exp_f32 v100, v100
    v_exp_f32 v101, v101
    v_exp_f32 v102, v102
    v_exp_f32 v103, v103
    s_andn2_b32 s6, s50, s44
    s_cbranch_scc1 ATT_cmid
    buffer_load_dword v207, v7, s[20:23], s49 offen sc1
    s_branch ATT_mid
ATT_cloop:
    v_mfma_f32_32x32x16_bf16 v[104:119], v[152:155], v[12:15], 0
    v_exp_f32 v88, v88
    v_exp_f32 v89, v89
    v_exp_f32 v90, v90
    v_smfmac_f32_32x32x32_bf16 v[72:87], v[192:195], v[136:143], v6
    v_exp_f32 v91, v91
    v_exp_f32 v92, v92
    v_exp_f32 v93, v93
    v_smfmac_f32_32x32x32_bf16 v[72:87], v[196:199], v[144:151], v6
    v_exp_f32 v94, v94
    v_exp_f32 v95, v95
    v_exp_f32 v96, v96
    v_exp_f32 v97, v97
    v_exp_f32 v98, v98
    v_exp_f32 v99, v99
    v_exp_f32 v100, v100
    v_exp_f32 v101, v101
    v_exp_f32 v102, v102
    v_exp_f32 v103, v103
ATT_cmid:
    v_mfma_f32_32x32x16_bf16 v[120:135], v[152:155], v[16:19], 0
    v_exp_f32 v104, v104
    v_exp_f32 v105, v105
    v_exp_f32 v106, v106
    v_smfmac_f32_32x32x32_bf16 v[24:39], v[156:159], v[88:95], v6
    v_exp_f32 v107, v107
    v_exp_f32 v108, v108
    v_exp_f32 v109, v109
    v_smfmac_f32_32x32x32_bf16 v[24:39], v[160:163], v[96:103], v6
    v_exp_f32 v110, v110
    v_exp_f32 v111, v111
    buffer_load_dwordx4 v[188:191], v4, s[12:15], s43 offen offset:1024 sc1
    buffer_load_dwordx4 v[192:195], v5, s[12:15], s43 offen offset:3200 sc1
    buffer_load_dwordx4 v[196:199], v5, s[12:15], s43 offen offset:3776 sc1
    v_exp_f32 v112, v112
    v_exp_f32 v113, v113
    v_exp_f32 v114, v114
    v_exp_f32 v115, v115
    v_exp_f32 v116, v116
    v_exp_f32 v117, v117
    v_exp_f32 v118, v118
    v_exp_f32 v119, v119
    v_mfma_f32_32x32x16_bf16 v[136:151], v[152:155], v[20:23], 0
    v_exp_f32 v120, v120
    v_exp_f32 v121, v121
    v_exp_f32 v122, v122
    v_smfmac_f32_32x32x32_bf16 v[40:55], v[156:159], v[104:111], v6
    v_exp_f32 v123, v123
    v_exp_f32 v124, v124
    v_exp_f32 v125, v125
    v_smfmac_f32_32x32x32_bf16 v[40:55], v[160:163], v[112:119], v6
    v_exp_f32 v126, v126
    v_exp_f32 v127, v127
    v_exp_f32 v128, v128
    v_exp_f32 v129, v129
    v_exp_f32 v130, v130
    v_exp_f32 v131, v131
    v_exp_f32 v132, v132
    v_exp_f32 v133, v133
    v_exp_f32 v134, v134
    v_exp_f32 v135, v135
    s_waitcnt vmcnt(6)
    v_mfma_f32_32x32x16_bf16 v[88:103], v[164:167], v[8:11], 0
    v_exp_f32 v136, v136
    v_exp_f32 v137, v137
    v_exp_f32 v138, v138
    v_smfmac_f32_32x32x32_bf16 v[56:71], v[156:159], v[120:127], v6
    v_exp_f32 v139, v139
    v_exp_f32 v140, v140
    v_exp_f32 v141, v141
    v_smfmac_f32_32x32x32_bf16 v[56:71], v[160:163], v[128:135], v6
    v_exp_f32 v142, v142
    v_exp_f32 v143, v143
    v_exp_f32 v144, v144
    v_exp_f32 v145, v145
    v_exp_f32 v146, v146
    v_exp_f32 v147, v147
    v_exp_f32 v148, v148
    v_exp_f32 v149, v149
    v_exp_f32 v150, v150
    v_exp_f32 v151, v151
    v_mfma_f32_32x32x16_bf16 v[104:119], v[164:167], v[12:15], 0
    v_exp_f32 v88, v88
    v_exp_f32 v89, v89
    v_exp_f32 v90, v90
    v_smfmac_f32_32x32x32_bf16 v[72:87], v[156:159], v[136:143], v6
    v_exp_f32 v91, v91
    v_exp_f32 v92, v92
    v_exp_f32 v93, v93
    v_smfmac_f32_32x32x32_bf16 v[72:87], v[160:163], v[144:151], v6
    v_exp_f32 v94, v94
    v_exp_f32 v95, v95
    s_andn2_b32 s6, s50, s44
    s_cbranch_scc1 A_rs_76
A_b1_77:
    s_and_b32 s6, s44, s50
    s_cbranch_scc0 A_rf_74
A_bk_75:
    s_ff1_i32_b32 s6, s6
    s_bitset0_b32 s50, s6
    s_mul_i32 s43, s6, 2176
A_b2_78:
    v_exp_f32 v96, v96
    v_exp_f32 v97, v97
    v_exp_f32 v98, v98
    v_exp_f32 v99, v99
    v_exp_f32 v100, v100
    v_exp_f32 v101, v101
    v_exp_f32 v102, v102
    v_exp_f32 v103, v103
    v_mfma_f32_32x32x16_bf16 v[120:135], v[164:167], v[16:19], 0
    v_exp_f32 v104, v104
    v_exp_f32 v105, v105
    v_exp_f32 v106, v106
    v_smfmac_f32_32x32x32_bf16 v[24:39], v[168:171], v[88:95], v6
    v_exp_f32 v107, v107
    v_exp_f32 v108, v108
    v_exp_f32 v109, v109
    v_smfmac_f32_32x32x32_bf16 v[24:39], v[172:175], v[96:103], v6
    v_exp_f32 v110, v110
    v_exp_f32 v111, v111
    buffer_load_dwordx4 v[152:155], v4, s[12:15], s43 offen offset:0 sc1
    buffer_load_dwordx4 v[156:159], v5, s[12:15], s43 offen offset:2048 sc1
    buffer_load_dwordx4 v[160:163], v5, s[12:15], s43 offen offset:2624 sc1
    v_exp_f32 v112, v112
    v_exp_f32 v113, v113
    v_exp_f32 v114, v114
    v_exp_f32 v115, v115
    v_exp_f32 v116, v116
    v_exp_f32 v117, v117
    v_exp_f32 v118, v118
    v_exp_f32 v119, v119
    v_mfma_f32_32x32x16_bf16 v[136:151], v[164:167], v[20:23], 0
    v_exp_f32 v120, v120
    v_exp_f32 v121, v121
    v_exp_f32 v122, v122
    v_smfmac_f32_32x32x32_bf16 v[40:55], v[168:171], v[104:111], v6
    v_exp_f32 v123, v123
    v_exp_f32 v124, v124
    v_exp_f32 v125, v125
    v_smfmac_f32_32x32x32_bf16 v[40:55], v[172:175], v[112:119], v6
    v_exp_f32 v126, v126
    v_exp_f32 v127, v127
    v_exp_f32 v128, v128
    v_exp_f32 v129, v129
    v_exp_f32 v130, v130
    v_exp_f32 v131, v131
    v_exp_f32 v132, v132
    v_exp_f32 v133, v133
    v_exp_f32 v134, v134
    v_exp_f32 v135, v135
    s_waitcnt vmcnt(6)
    v_mfma_f32_32x32x16_bf16 v[88:103], v[176:179], v[8:11], 0
    v_exp_f32 v136, v136
    v_exp_f32 v137, v137
    v_exp_f32 v138, v138
    v_smfmac_f32_32x32x32_bf16 v[56:71], v[168:171], v[120:127], v6
    v_exp_f32 v139, v139
    v_exp_f32 v140, v140
    v_exp_f32 v141, v141
    v_smfmac_f32_32x32x32_bf16 v[56:71], v[172:175], v[128:135], v6
    v_exp_f32 v142, v142
    v_exp_f32 v143, v143
    v_exp_f32 v144, v144
    v_exp_f32 v145, v145
    v_exp_f32 v146, v146
    v_exp_f32 v147, v147
    v_exp_f32 v148, v148
    v_exp_f32 v149, v149
    v_exp_f32 v150, v150
    v_exp_f32 v151, v151
    v_mfma_f32_32x32x16_bf16 v[104:119], v[176:179], v[12:15], 0
    v_exp_f32 v88, v88
    v_exp_f32 v89, v89
    v_exp_f32 v90, v90
    v_smfmac_f32_32x32x32_bf16 v[72:87], v[168:171], v[136:143], v6
    v_exp_f32 v91, v91
    v_exp_f32 v92, v92
    v_exp_f32 v93, v93
    v_smfmac_f32_32x32x32_bf16 v[72:87], v[172:175], v[144:151], v6
    v_exp_f32 v94, v94
    v_exp_f32 v95, v95
    v_exp_f32 v96, v96
    v_exp_f32 v97, v97
    v_exp_f32 v98, v98
    v_exp_f32 v99, v99
    v_exp_f32 v100, v100
    v_exp_f32 v101, v101
    v_exp_f32 v102, v102
    v_exp_f32 v103, v103
    v_mfma_f32_32x32x16_bf16 v[120:135], v[176:179], v[16:19], 0
    v_exp_f32 v104, v104
    v_exp_f32 v105, v105
    v_exp_f32 v106, v106
    v_smfmac_f32_32x32x32_bf16 v[24:39], v[180:183], v[88:95], v6
    v_exp_f32 v107, v107
    v_exp_f32 v108, v108
    v_exp_f32 v109, v109
    v_smfmac_f32_32x32x32_bf16 v[24:39], v[184:187], v[96:103], v6
    v_exp_f32 v110, v110
    v_exp_f32 v111, v111
    buffer_load_dwordx4 v[164:167], v4, s[12:15], s43 offen offset:1024 sc1
    buffer_load_dwordx4 v[168:171], v5, s[12:15], s43 offen offset:3200 sc1
    buffer_load_dwordx4 v[172:175], v5, s[12:15], s43 offen offset:3776 sc1
    v_exp_f32 v112, v112
    v_exp_f32 v113, v113
    v_exp_f32 v114, v114
    v_exp_f32 v115, v115
    v_exp_f32 v116, v116
    v_exp_f32 v117, v117
    v_exp_f32 v118, v118
    v_exp_f32 v119, v119
    v_mfma_f32_32x32x16_bf16 v[136:151], v[176:179], v[20:23], 0
    v_exp_f32 v120, v120
    v_exp_f32 v121, v121
    v_exp_f32 v122, v122
    v_smfmac_f32_32x32x32_bf16 v[40:55], v[180:183], v[104:111], v6
    v_exp_f32 v123, v123
    v_exp_f32 v124, v124
    v_exp_f32 v125, v125
    v_smfmac_f32_32x32x32_bf16 v[40:55], v[184:187], v[112:119], v6
    v_exp_f32 v126, v126
    v_exp_f32 v127, v127
    v_exp_f32 v128, v128
    v_exp_f32 v129, v129
    v_exp_f32 v130, v130
    v_exp_f32 v131, v131
    v_exp_f32 v132, v132
    v_exp_f32 v133, v133
    v_exp_f32 v134, v134
    v_exp_f32 v135, v135
    s_waitcnt vmcnt(6)
    v_mfma_f32_32x32x16_bf16 v[88:103], v[188:191], v[8:11], 0
    v_exp_f32 v136, v136
    v_exp_f32 v137, v137
    v_exp_f32 v138, v138
    v_smfmac_f32_32x32x32_bf16 v[56:71], v[180:183], v[120:127], v6
    v_exp_f32 v139, v139
    v_exp_f32 v140, v140
    v_exp_f32 v141, v141
    v_smfmac_f32_32x32x32_bf16 v[56:71], v[184:187], v[128:135], v6
    v_exp_f32 v142, v142
    v_exp_f32 v143, v143
    v_exp_f32 v144, v144
    v_exp_f32 v145, v145
    v_exp_f32 v146, v146
    v_exp_f32 v147, v147
    v_exp_f32 v148, v148
    v_exp_f32 v149, v149
    v_exp_f32 v150, v150
    v_exp_f32 v151, v151
    v_mfma_f32_32x32x16_bf16 v[104:119], v[188:191], v[12:15], 0
    v_exp_f32 v88, v88
    v_exp_f32 v89, v89
    v_exp_f32 v90, v90
    v_smfmac_f32_32x32x32_bf16 v[72:87], v[180:183], v[136:143], v6
    v_exp_f32 v91, v91
    v_exp_f32 v92, v92
    v_exp_f32 v93, v93
    v_smfmac_f32_32x32x32_bf16 v[72:87], v[184:187], v[144:151], v6
    v_exp_f32 v94, v94
    v_exp_f32 v95, v95
    s_andn2_b32 s6, s50, s44
    s_cbranch_scc1 A_rs_81
A_b1_82:
    s_and_b32 s6, s44, s50
    s_cbranch_scc0 A_rf_79
A_bk_80:
    s_ff1_i32_b32 s6, s6
    s_bitset0_b32 s50, s6
    s_mul_i32 s43, s6, 2176
A_b2_83:
    v_exp_f32 v96, v96
    v_exp_f32 v97, v97
    v_exp_f32 v98, v98
    v_exp_f32 v99, v99
    v_exp_f32 v100, v100
    v_exp_f32 v101, v101
    v_exp_f32 v102, v102
    v_exp_f32 v103, v103
    v_mfma_f32_32x32x16_bf16 v[120:135], v[188:191], v[16:19], 0
    v_exp_f32 v104, v104
    v_exp_f32 v105, v105
    v_exp_f32 v106, v106
    v_smfmac_f32_32x32x32_bf16 v[24:39], v[192:195], v[88:95], v6
    v_exp_f32 v107, v107
    v_exp_f32 v108, v108
    v_exp_f32 v109, v109
    v_smfmac_f32_32x32x32_bf16 v[24:39], v[196:199], v[96:103], v6
    v_exp_f32 v110, v110
    v_exp_f32 v111, v111
    buffer_load_dwordx4 v[176:179], v4, s[12:15], s43 offen offset:0 sc1
    buffer_load_dwordx4 v[180:183], v5, s[12:15], s43 offen offset:2048 sc1
    buffer_load_dwordx4 v[184:187], v5, s[12:15], s43 offen offset:2624 sc1
    v_exp_f32 v112, v112
    v_exp_f32 v113, v113
    v_exp_f32 v114, v114
    v_exp_f32 v115, v115
    v_exp_f32 v116, v116
    v_exp_f32 v117, v117
    v_exp_f32 v118, v118
    v_exp_f32 v119, v119
    v_mfma_f32_32x32x16_bf16 v[136:151], v[188:191], v[20:23], 0
    v_exp_f32 v120, v120
    v_exp_f32 v121, v121
    v_exp_f32 v122, v122
    v_smfmac_f32_32x32x32_bf16 v[40:55], v[192:195], v[104:111], v6
    v_exp_f32 v123, v123
    v_exp_f32 v124, v124
    v_exp_f32 v125, v125
    v_smfmac_f32_32x32x32_bf16 v[40:55], v[196:199], v[112:119], v6
    v_exp_f32 v126, v126
    v_exp_f32 v127, v127
    v_exp_f32 v128, v128
    v_exp_f32 v129, v129
    v_exp_f32 v130, v130
    v_exp_f32 v131, v131
    v_exp_f32 v132, v132
    v_exp_f32 v133, v133
    v_exp_f32 v134, v134
    v_exp_f32 v135, v135
    s_waitcnt vmcnt(6)
    v_mfma_f32_32x32x16_bf16 v[88:103], v[152:155], v[8:11], 0
    v_exp_f32 v136, v136
    v_exp_f32 v137, v137
    v_exp_f32 v138, v138
    v_smfmac_f32_32x32x32_bf16 v[56:71], v[192:195], v[120:127], v6
    v_exp_f32 v139, v139
    v_exp_f32 v140, v140
    v_exp_f32 v141, v141
    v_smfmac_f32_32x32x32_bf16 v[56:71], v[196:199], v[128:135], v6
    v_exp_f32 v142, v142
    v_exp_f32 v143, v143
    v_exp_f32 v144, v144
    v_exp_f32 v145, v145
    v_exp_f32 v146, v146
    v_exp_f32 v147, v147
    v_exp_f32 v148, v148
    v_exp_f32 v149, v149
    v_exp_f32 v150, v150
    v_exp_f32 v151, v151
    s_sub_u32 s52, s52, 1
    s_cmp_eq_u32 s52, 0
    s_cbranch_scc1 ATT_exit
    s_andn2_b32 s6, s50, s44
    s_cbranch_scc1 ATT_cloop
    buffer_load_dword v207, v7, s[20:23], s49 offen sc1
    .p2align 6
ATT_loop:
    v_mfma_f32_32x32x16_bf16 v[104:119], v[152:155], v[12:15], 0
    v_exp_f32 v88, v88
    v_exp_f32 v89, v89
    v_exp_f32 v90, v90
    v_smfmac_f32_32x32x32_bf16 v[72:87], v[192:195], v[136:143], v6
    v_exp_f32 v91, v91
    v_exp_f32 v92, v92
    v_exp_f32 v93, v93
    v_smfmac_f32_32x32x32_bf16 v[72:87], v[196:199], v[144:151], v6
    v_exp_f32 v94, v94
    v_exp_f32 v95, v95
    v_exp_f32 v96, v96
    v_exp_f32 v97, v97
    v_exp_f32 v98, v98
    v_exp_f32 v99, v99
    v_exp_f32 v100, v100
    v_exp_f32 v101, v101
    v_exp_f32 v102, v102
    v_exp_f32 v103, v103
ATT_mid:
    v_mfma_f32_32x32x16_bf16 v[120:135], v[152:155], v[16:19], 0
    v_exp_f32 v104, v104
    v_exp_f32 v105, v105
    v_exp_f32 v106, v106
    v_smfmac_f32_32x32x32_bf16 v[24:39], v[156:159], v[88:95], v6
    v_exp_f32 v107, v107
    v_exp_f32 v108, v108
    v_exp_f32 v109, v109
    v_smfmac_f32_32x32x32_bf16 v[24:39], v[160:163], v[96:103], v6
    v_exp_f32 v110, v110
    v_exp_f32 v111, v111
    buffer_load_dwordx4 v[188:191], v4, s[12:15], s43 offen offset:1024 sc1
    buffer_load_dwordx4 v[192:195], v5, s[12:15], s43 offen offset:3200 sc1
    buffer_load_dwordx4 v[196:199], v5, s[12:15], s43 offen offset:3776 sc1
    v_exp_f32 v112, v112
    v_exp_f32 v113, v113
    v_exp_f32 v114, v114
    v_exp_f32 v115, v115
    v_exp_f32 v116, v116
    v_exp_f32 v117, v117
    v_exp_f32 v118, v118
    v_exp_f32 v119, v119
    v_mfma_f32_32x32x16_bf16 v[136:151], v[152:155], v[20:23], 0
    v_exp_f32 v120, v120
    v_exp_f32 v121, v121
    v_exp_f32 v122, v122
    v_smfmac_f32_32x32x32_bf16 v[40:55], v[156:159], v[104:111], v6
    v_exp_f32 v123, v123
    v_exp_f32 v124, v124
    v_exp_f32 v125, v125
    v_smfmac_f32_32x32x32_bf16 v[40:55], v[160:163], v[112:119], v6
    v_exp_f32 v126, v126
    v_exp_f32 v127, v127
    v_exp_f32 v128, v128
    v_exp_f32 v129, v129
    v_exp_f32 v130, v130
    v_exp_f32 v131, v131
    v_exp_f32 v132, v132
    v_exp_f32 v133, v133
    v_exp_f32 v134, v134
    v_exp_f32 v135, v135
    s_waitcnt vmcnt(6)
    v_mfma_f32_32x32x16_bf16 v[88:103], v[164:167], v[8:11], 0
    v_exp_f32 v136, v136
    v_exp_f32 v137, v137
    v_exp_f32 v138, v138
    v_smfmac_f32_32x32x32_bf16 v[56:71], v[156:159], v[120:127], v6
    v_exp_f32 v139, v139
    v_exp_f32 v140, v140
    v_exp_f32 v141, v141
    v_smfmac_f32_32x32x32_bf16 v[56:71], v[160:163], v[128:135], v6
    v_exp_f32 v142, v142
    v_exp_f32 v143, v143
    v_exp_f32 v144, v144
    v_exp_f32 v145, v145
    v_exp_f32 v146, v146
    v_exp_f32 v147, v147
    v_exp_f32 v148, v148
    v_exp_f32 v149, v149
    v_exp_f32 v150, v150
    v_exp_f32 v151, v151
    v_mfma_f32_32x32x16_bf16 v[104:119], v[164:167], v[12:15], 0
    v_exp_f32 v88, v88
    v_exp_f32 v89, v89
    v_exp_f32 v90, v90
    v_smfmac_f32_32x32x32_bf16 v[72:87], v[156:159], v[136:143], v6
    v_exp_f32 v91, v91
    v_exp_f32 v92, v92
    v_exp_f32 v93, v93
    v_smfmac_f32_32x32x32_bf16 v[72:87], v[160:163], v[144:151], v6
    v_exp_f32 v94, v94
    v_exp_f32 v95, v95
    s_ff1_i32_b64 s6, s[50:51]
    s_bitset0_b64 s[50:51], s6
    s_mul_i32 s43, s6, 2176
    v_exp_f32 v96, v96
    v_exp_f32 v97, v97
    v_exp_f32 v98, v98
    v_exp_f32 v99, v99
    v_exp_f32 v100, v100
    v_exp_f32 v101, v101
    v_exp_f32 v102, v102
    v_exp_f32 v103, v103
    v_mfma_f32_32x32x16_bf16 v[120:135], v[164:167], v[16:19], 0
    v_exp_f32 v104, v104
    v_exp_f32 v105, v105
    v_exp_f32 v106, v106
    v_smfmac_f32_32x32x32_bf16 v[24:39], v[168:171], v[88:95], v6
    v_exp_f32 v107, v107
    v_exp_f32 v108, v108
    v_exp_f32 v109, v109
    v_smfmac_f32_32x32x32_bf16 v[24:39], v[172:175], v[96:103], v6
    v_exp_f32 v110, v110
    v_exp_f32 v111, v111
    buffer_load_dwordx4 v[152:155], v4, s[12:15], s43 offen offset:0 sc1
    buffer_load_dwordx4 v[156:159], v5, s[12:15], s43 offen offset:2048 sc1
    buffer_load_dwordx4 v[160:163], v5, s[12:15], s43 offen offset:2624 sc1
    v_exp_f32 v112, v112
    v_exp_f32 v113, v113
    v_exp_f32 v114, v114
    v_exp_f32 v115, v115
    v_exp_f32 v116, v116
    v_exp_f32 v117, v117
    v_exp_f32 v118, v118
    v_exp_f32 v119, v119
    v_mfma_f32_32x32x16_bf16 v[136:151], v[164:167], v[20:23], 0
    v_exp_f32 v120, v120
    v_exp_f32 v121, v121
    v_exp_f32 v122, v122
    v_smfmac_f32_32x32x32_bf16 v[40:55], v[168:171], v[104:111], v6
    v_exp_f32 v123, v123
    v_exp_f32 v124, v124
    v_exp_f32 v125, v125
    v_smfmac_f32_32x32x32_bf16 v[40:55], v[172:175], v[112:119], v6
    v_exp_f32 v126, v126
    v_exp_f32 v127, v127
    v_exp_f32 v128, v128
    v_exp_f32 v129, v129
    v_exp_f32 v130, v130
    v_exp_f32 v131, v131
    v_exp_f32 v132, v132
    v_exp_f32 v133, v133
    v_exp_f32 v134, v134
    v_exp_f32 v135, v135
    s_waitcnt vmcnt(6)
    v_mfma_f32_32x32x16_bf16 v[88:103], v[176:179], v[8:11], 0
    v_exp_f32 v136, v136
    v_exp_f32 v137, v137
    v_exp_f32 v138, v138
    v_smfmac_f32_32x32x32_bf16 v[56:71], v[168:171], v[120:127], v6
    v_exp_f32 v139, v139
    v_exp_f32 v140, v140
    v_exp_f32 v141, v141
    v_smfmac_f32_32x32x32_bf16 v[56:71], v[172:175], v[128:135], v6
    v_exp_f32 v142, v142
    v_exp_f32 v143, v143
    v_exp_f32 v144, v144
    v_exp_f32 v145, v145
    v_exp_f32 v146, v146
    v_exp_f32 v147, v147
    v_exp_f32 v148, v148
    v_exp_f32 v149, v149
    v_exp_f32 v150, v150
    v_exp_f32 v151, v151
    v_mfma_f32_32x32x16_bf16 v[104:119], v[176:179], v[12:15], 0
    v_exp_f32 v88, v88
    v_exp_f32 v89, v89
    v_exp_f32 v90, v90
    v_smfmac_f32_32x32x32_bf16 v[72:87], v[168:171], v[136:143], v6
    v_exp_f32 v91, v91
    v_exp_f32 v92, v92
    v_exp_f32 v93, v93
    v_smfmac_f32_32x32x32_bf16 v[72:87], v[172:175], v[144:151], v6
    v_exp_f32 v94, v94
    v_exp_f32 v95, v95
    v_exp_f32 v96, v96
    v_exp_f32 v97, v97
    v_exp_f32 v98, v98
    v_exp_f32 v99, v99
    v_exp_f32 v100, v100
    v_exp_f32 v101, v101
    v_exp_f32 v102, v102
    v_exp_f32 v103, v103
    v_mfma_f32_32x32x16_bf16 v[120:135], v[176:179], v[16:19], 0
    v_exp_f32 v104, v104
    v_exp_f32 v105, v105
    v_exp_f32 v106, v106
    v_smfmac_f32_32x32x32_bf16 v[24:39], v[180:183], v[88:95], v6
    v_exp_f32 v107, v107
    v_exp_f32 v108, v108
    v_exp_f32 v109, v109
    v_smfmac_f32_32x32x32_bf16 v[24:39], v[184:187], v[96:103], v6
    v_exp_f32 v110, v110
    v_exp_f32 v111, v111
    buffer_load_dwordx4 v[164:167], v4, s[12:15], s43 offen offset:1024 sc1
    buffer_load_dwordx4 v[168:171], v5, s[12:15], s43 offen offset:3200 sc1
    buffer_load_dwordx4 v[172:175], v5, s[12:15], s43 offen offset:3776 sc1
    v_exp_f32 v112, v112
    v_exp_f32 v113, v113
    v_exp_f32 v114, v114
    v_exp_f32 v115, v115
    v_exp_f32 v116, v116
    v_exp_f32 v117, v117
    v_exp_f32 v118, v118
    v_exp_f32 v119, v119
    v_mfma_f32_32x32x16_bf16 v[136:151], v[176:179], v[20:23], 0
    v_exp_f32 v120, v120
    v_exp_f32 v121, v121
    v_exp_f32 v122, v122
    v_smfmac_f32_32x32x32_bf16 v[40:55], v[180:183], v[104:111], v6
    v_exp_f32 v123, v123
    v_exp_f32 v124, v124
    v_exp_f32 v125, v125
    v_smfmac_f32_32x32x32_bf16 v[40:55], v[184:187], v[112:119], v6
    v_exp_f32 v126, v126
    v_exp_f32 v127, v127
    v_exp_f32 v128, v128
    v_exp_f32 v129, v129
    v_exp_f32 v130, v130
    v_exp_f32 v131, v131
    v_exp_f32 v132, v132
    v_exp_f32 v133, v133
    v_exp_f32 v134, v134
    v_exp_f32 v135, v135
    s_waitcnt vmcnt(6)
    v_mfma_f32_32x32x16_bf16 v[88:103], v[188:191], v[8:11], 0
    v_exp_f32 v136, v136
    v_exp_f32 v137, v137
    v_exp_f32 v138, v138
    v_smfmac_f32_32x32x32_bf16 v[56:71], v[180:183], v[120:127], v6
    v_exp_f32 v139, v139
    v_exp_f32 v140, v140
    v_exp_f32 v141, v141
    v_smfmac_f32_32x32x32_bf16 v[56:71], v[184:187], v[128:135], v6
    v_exp_f32 v142, v142
    v_exp_f32 v143, v143
    v_exp_f32 v144, v144
    v_exp_f32 v145, v145
    v_exp_f32 v146, v146
    v_exp_f32 v147, v147
    v_exp_f32 v148, v148
    v_exp_f32 v149, v149
    v_exp_f32 v150, v150
    v_exp_f32 v151, v151
    v_mfma_f32_32x32x16_bf16 v[104:119], v[188:191], v[12:15], 0
    v_exp_f32 v88, v88
    v_exp_f32 v89, v89
    v_exp_f32 v90, v90
    v_smfmac_f32_32x32x32_bf16 v[72:87], v[180:183], v[136:143], v6
    v_exp_f32 v91, v91
    v_exp_f32 v92, v92
    v_exp_f32 v93, v93
    v_smfmac_f32_32x32x32_bf16 v[72:87], v[184:187], v[144:151], v6
    v_exp_f32 v94, v94
    v_exp_f32 v95, v95
    s_ff1_i32_b64 s6, s[50:51]
    s_bitset0_b64 s[50:51], s6
    s_mul_i32 s43, s6, 2176
    v_exp_f32 v96, v96
    v_exp_f32 v97, v97
    v_exp_f32 v98, v98
    v_exp_f32 v99, v99
    v_exp_f32 v100, v100
    v_exp_f32 v101, v101
    v_exp_f32 v102, v102
    v_exp_f32 v103, v103
    v_mfma_f32_32x32x16_bf16 v[120:135], v[188:191], v[16:19], 0
    v_exp_f32 v104, v104
    v_exp_f32 v105, v105
    v_exp_f32 v106, v106
    v_smfmac_f32_32x32x32_bf16 v[24:39], v[192:195], v[88:95], v6
    v_exp_f32 v107, v107
    v_exp_f32 v108, v108
    v_exp_f32 v109, v109
    v_smfmac_f32_32x32x32_bf16 v[24:39], v[196:199], v[96:103], v6
    v_exp_f32 v110, v110
    v_exp_f32 v111, v111
    buffer_load_dwordx4 v[176:179], v4, s[12:15], s43 offen offset:0 sc1
    buffer_load_dwordx4 v[180:183], v5, s[12:15], s43 offen offset:2048 sc1
    buffer_load_dwordx4 v[184:187], v5, s[12:15], s43 offen offset:2624 sc1
    v_exp_f32 v112, v112
    v_exp_f32 v113, v113
    v_exp_f32 v114, v114
    v_exp_f32 v115, v115
    v_exp_f32 v116, v116
    v_exp_f32 v117, v117
    v_exp_f32 v118, v118
    v_exp_f32 v119, v119
    v_mfma_f32_32x32x16_bf16 v[136:151], v[188:191], v[20:23], 0
    v_exp_f32 v120, v120
    v_exp_f32 v121, v121
    v_exp_f32 v122, v122
    v_smfmac_f32_32x32x32_bf16 v[40:55], v[192:195], v[104:111], v6
    v_exp_f32 v123, v123
    v_exp_f32 v124, v124
    v_exp_f32 v125, v125
    v_smfmac_f32_32x32x32_bf16 v[40:55], v[196:199], v[112:119], v6
    v_exp_f32 v126, v126
    v_exp_f32 v127, v127
    v_exp_f32 v128, v128
    v_exp_f32 v129, v129
    v_exp_f32 v130, v130
    v_exp_f32 v131, v131
    v_exp_f32 v132, v132
    v_exp_f32 v133, v133
    v_exp_f32 v134, v134
    v_exp_f32 v135, v135
    s_waitcnt vmcnt(6)
    v_mfma_f32_32x32x16_bf16 v[88:103], v[152:155], v[8:11], 0
    v_exp_f32 v136, v136
    v_exp_f32 v137, v137
    v_exp_f32 v138, v138
    v_smfmac_f32_32x32x32_bf16 v[56:71], v[192:195], v[120:127], v6
    v_exp_f32 v139, v139
    v_exp_f32 v140, v140
    v_exp_f32 v141, v141
    v_smfmac_f32_32x32x32_bf16 v[56:71], v[196:199], v[128:135], v6
    v_exp_f32 v142, v142
    v_exp_f32 v143, v143
    v_exp_f32 v144, v144
    v_exp_f32 v145, v145
    v_exp_f32 v146, v146
    v_exp_f32 v147, v147
    v_exp_f32 v148, v148
    v_exp_f32 v149, v149
    v_exp_f32 v150, v150
    v_exp_f32 v151, v151
    s_sub_u32 s52, s52, 1
    s_cmp_lg_u32 s52, 0
    s_cbranch_scc1 ATT_loop
ATT_exit:
    ds_read_b32 v221, v200 offset:0
    v_smfmac_f32_32x32x32_bf16 v[72:87], v[192:195], v[136:143], v6
    v_smfmac_f32_32x32x32_bf16 v[72:87], v[196:199], v[144:151], v6
    v_mov_b32 v3, 0x45100000
    s_waitcnt lgkmcnt(0)
    v_readfirstlane_b32 s6, v221
    v_mul_f32 v207, v206, v207
    v_cmp_nle_f32 vcc, v207, v3
    s_cmp_ge_u32 s6, 72
    s_cbranch_scc1 ATT_g1ok
LW_84:
    ds_read_b32 v221, v200 offset:0
    s_waitcnt lgkmcnt(0)
    v_readfirstlane_b32 s6, v221
    s_cmp_ge_u32 s6, 72
    s_cbranch_scc1 LWd_85
    s_sleep 1
    s_sub_u32 s98, s98, 1
    s_cbranch_scc0 LW_84
LWd_85:
ATT_g1ok:
    s_cmp_lg_u64 vcc, 0
    s_cselect_b32 s54, 2, 1
    s_nop 2
ATT_epi:
    v_mov_b32 v219, s54
    ds_write_b128 v211, v[56:59] offset:0
    ds_write_b128 v211, v[60:63] offset:1024
    ds_write_b32 v216, v64 offset:2048
    ds_write_b128 v211, v[72:75] offset:2304
    ds_write_b128 v211, v[76:79] offset:3328
    ds_write_b32 v216, v80 offset:4352
    ds_write_b32 v202, v219 offset:16
    s_add_u32 s20, s80, 2097152
    s_addc_u32 s21, s81, 0
    s_mov_b32 s22, 2097152
    s_mov_b32 s23, 0x20000
LW_86:
    ds_read_b32 v221, v203 offset:16
    s_waitcnt lgkmcnt(0)
    v_readfirstlane_b32 s6, v221
    s_cmp_ge_u32 s6, s53
    s_cbranch_scc1 LWd_87
    s_sleep 1
    s_sub_u32 s98, s98, 1
    s_cbranch_scc0 LW_86
LWd_87:
    s_max_u32 s6, s6, s54
    s_cmp_eq_u32 s6, 2
    s_cbranch_scc1 ATT_slow
    s_cmp_gt_u32 s6, s54
    s_cbranch_scc1 ATT_slow
    ds_read_b32 v96, v218 offset:2048
    ds_read_b32 v108, v218 offset:4352
    ds_read_b128 v[88:91], v217 offset:0
    ds_read_b128 v[92:95], v217 offset:1024
    ds_read_b128 v[100:103], v217 offset:2304
    ds_read_b128 v[104:107], v217 offset:3328
    s_waitcnt lgkmcnt(4)
    v_add_f32 v96, v96, v32
    v_add_f32 v108, v108, v48
    v_rcp_f32 v96, v96
    v_rcp_f32 v108, v108
    s_waitcnt lgkmcnt(2)
    v_add_f32 v88, v88, v24
    v_add_f32 v89, v89, v25
    v_add_f32 v90, v90, v26
    v_add_f32 v91, v91, v27
    v_add_f32 v92, v92, v28
    v_add_f32 v93, v93, v29
    v_add_f32 v94, v94, v30
    v_add_f32 v95, v95, v31
    v_mul_f32 v88, v88, v96
    v_mul_f32 v89, v89, v96
    v_mul_f32 v90, v90, v96
    v_mul_f32 v91, v91, v96
    v_mul_f32 v92, v92, v96
    v_mul_f32 v93, v93, v96
    v_mul_f32 v94, v94, v96
    v_mul_f32 v95, v95, v96
    v_cvt_pk_bf16_f32 v120, v88, v89
    v_cvt_pk_bf16_f32 v121, v90, v91
    v_cvt_pk_bf16_f32 v122, v92, v93
    v_cvt_pk_bf16_f32 v123, v94, v95
    buffer_store_dwordx4 v[120:123], v4, s[20:23], s7 offen offset:0 sc1
    s_waitcnt lgkmcnt(0)
    v_add_f32 v100, v100, v40
    v_add_f32 v101, v101, v41
    v_add_f32 v102, v102, v42
    v_add_f32 v103, v103, v43
    v_add_f32 v104, v104, v44
    v_add_f32 v105, v105, v45
    v_add_f32 v106, v106, v46
    v_add_f32 v107, v107, v47
    v_mul_f32 v100, v100, v108
    v_mul_f32 v101, v101, v108
    v_mul_f32 v102, v102, v108
    v_mul_f32 v103, v103, v108
    v_mul_f32 v104, v104, v108
    v_mul_f32 v105, v105, v108
    v_mul_f32 v106, v106, v108
    v_mul_f32 v107, v107, v108
    v_cvt_pk_bf16_f32 v124, v100, v101
    v_cvt_pk_bf16_f32 v125, v102, v103
    v_cvt_pk_bf16_f32 v126, v104, v105
    v_cvt_pk_bf16_f32 v127, v106, v107
    buffer_store_dwordx4 v[124:127], v4, s[20:23], s7 offen offset:1024 sc1
    s_lshl_b32 s6, s4, 3
    s_add_u32 s6, s6, s5
    s_lshl_b32 s6, s6, 5
    s_add_u32 s6, s6, s3
    s_lshl_b32 s6, s6, 2
    s_add_u32 s6, s6, 0x2000
    v_mov_b32 v2, s46
    v_mov_b32 v3, 0
    s_mov_b64 exec, 1
    s_waitcnt vmcnt(0)
    buffer_store_dword v2, v3, s[28:31], s6 offen sc1
    s_mov_b64 exec, -1
    s_setprio 0
    ds_read_b64_tr_b16 v[168:169], v232 offset:0
    ds_read_b64_tr_b16 v[170:171], v232 offset:1024
    ds_read_b64_tr_b16 v[172:173], v233 offset:0
    ds_read_b64_tr_b16 v[174:175], v233 offset:1024
    ds_read_b64_tr_b16 v[176:177], v232 offset:2048
    ds_read_b64_tr_b16 v[178:179], v232 offset:3072
    ds_read_b64_tr_b16 v[180:181], v233 offset:2048
    ds_read_b64_tr_b16 v[182:183], v233 offset:3072
    ds_read_b64_tr_b16 v[184:185], v232 offset:4096
    ds_read_b64_tr_b16 v[186:187], v232 offset:5120
    ds_read_b64_tr_b16 v[188:189], v233 offset:4096
    ds_read_b64_tr_b16 v[190:191], v233 offset:5120
    s_waitcnt lgkmcnt(8)
    ds_read_b64_tr_b16 v[192:193], v232 offset:6144
    ds_read_b64_tr_b16 v[194:195], v232 offset:7168
    ds_read_b64_tr_b16 v[196:197], v233 offset:6144
    ds_read_b64_tr_b16 v[198:199], v233 offset:7168
    s_waitcnt lgkmcnt(8)
    ds_read_b64_tr_b16 v[200:201], v232 offset:8192
    ds_read_b64_tr_b16 v[202:203], v232 offset:9216
    ds_read_b64_tr_b16 v[204:205], v233 offset:8192
    ds_read_b64_tr_b16 v[206:207], v233 offset:9216
    s_waitcnt lgkmcnt(8)
    ds_read_b64_tr_b16 v[208:209], v232 offset:10240
    ds_read_b64_tr_b16 v[210:211], v232 offset:11264
    ds_read_b64_tr_b16 v[212:213], v233 offset:10240
    ds_read_b64_tr_b16 v[214:215], v233 offset:11264
    s_waitcnt lgkmcnt(8)
    ds_read_b64_tr_b16 v[216:217], v232 offset:12288
    ds_read_b64_tr_b16 v[218:219], v232 offset:13312
    ds_read_b64_tr_b16 v[220:221], v233 offset:12288
    ds_read_b64_tr_b16 v[222:223], v233 offset:13312
    s_waitcnt lgkmcnt(8)
    ds_read_b64_tr_b16 v[224:225], v232 offset:14336
    ds_read_b64_tr_b16 v[226:227], v232 offset:15360
    ds_read_b64_tr_b16 v[228:229], v233 offset:14336
    ds_read_b64_tr_b16 v[230:231], v233 offset:15360
    s_branch TAIL
A_rf_64:
    s_cmp_eq_u32 s50, 0
    s_cbranch_scc1 A_jk_89
    s_mov_b32 s47, 200000
    s_mov_b32 exec_hi, 0
A_rp_88:
    s_waitcnt vmcnt(0)
    v_xor_b32 v212, s46, v212
    v_xor_b32 v213, s46, v213
    v_xor_b32 v214, s46, v214
    v_xor_b32 v215, s46, v215
    v_or_b32 v212, v212, v213
    v_or3_b32 v212, v212, v214, v215
    v_cmp_eq_u32 vcc, 0, v212
    buffer_load_dwordx4 v[212:215], v208, s[28:31], s48 offen sc1
    s_sub_u32 s47, s47, 1
    s_cbranch_scc1 A_jk_89
    s_lshr_b32 s6, vcc_lo, 1
    s_and_b32 s44, s6, vcc_lo
    s_and_b32 s6, s44, s50
    s_mov_b32 exec_hi, -1
    s_cbranch_scc1 A_bk_65
    s_mov_b32 exec_hi, 0
    s_sleep 2
    s_branch A_rp_88
A_jk_89:
    s_mov_b64 exec, -1
    s_mov_b32 s43, 0x10000000
    s_branch A_b2_68
A_rf_69:
    s_cmp_eq_u32 s50, 0
    s_cbranch_scc1 A_jk_91
    s_mov_b32 s47, 200000
    s_mov_b32 exec_hi, 0
A_rp_90:
    s_waitcnt vmcnt(0)
    v_xor_b32 v212, s46, v212
    v_xor_b32 v213, s46, v213
    v_xor_b32 v214, s46, v214
    v_xor_b32 v215, s46, v215
    v_or_b32 v212, v212, v213
    v_or3_b32 v212, v212, v214, v215
    v_cmp_eq_u32 vcc, 0, v212
    buffer_load_dwordx4 v[212:215], v208, s[28:31], s48 offen sc1
    s_sub_u32 s47, s47, 1
    s_cbranch_scc1 A_jk_91
    s_lshr_b32 s6, vcc_lo, 1
    s_and_b32 s44, s6, vcc_lo
    s_and_b32 s6, s44, s50
    s_mov_b32 exec_hi, -1
    s_cbranch_scc1 A_bk_70
    s_mov_b32 exec_hi, 0
    s_sleep 2
    s_branch A_rp_90
A_jk_91:
    s_mov_b64 exec, -1
    s_mov_b32 s43, 0x10000000
    s_branch A_b2_73
A_rs_76:
    s_mov_b32 exec_hi, 0
    v_xor_b32 v212, s46, v212
    v_xor_b32 v213, s46, v213
    v_xor_b32 v214, s46, v214
    v_xor_b32 v215, s46, v215
    v_or_b32 v212, v212, v213
    v_or3_b32 v212, v212, v214, v215
    v_cmp_eq_u32 vcc, 0, v212
    buffer_load_dwordx4 v[212:215], v208, s[28:31], s48 offen sc1
    s_mov_b32 exec_hi, -1
    s_lshr_b32 s6, vcc_lo, 1
    s_and_b32 s44, s6, vcc_lo
    s_branch A_b1_77
A_rf_74:
    s_cmp_eq_u32 s50, 0
    s_cbranch_scc1 A_jk_93
    s_mov_b32 s47, 200000
    s_mov_b32 exec_hi, 0
A_rp_92:
    s_waitcnt vmcnt(0)
    v_xor_b32 v212, s46, v212
    v_xor_b32 v213, s46, v213
    v_xor_b32 v214, s46, v214
    v_xor_b32 v215, s46, v215
    v_or_b32 v212, v212, v213
    v_or3_b32 v212, v212, v214, v215
    v_cmp_eq_u32 vcc, 0, v212
    buffer_load_dwordx4 v[212:215], v208, s[28:31], s48 offen sc1
    s_sub_u32 s47, s47, 1
    s_cbranch_scc1 A_jk_93
    s_lshr_b32 s6, vcc_lo, 1
    s_and_b32 s44, s6, vcc_lo
    s_and_b32 s6, s44, s50
    s_mov_b32 exec_hi, -1
    s_cbranch_scc1 A_bk_75
    s_mov_b32 exec_hi, 0
    s_sleep 2
    s_branch A_rp_92
A_jk_93:
    s_mov_b64 exec, -1
    s_mov_b32 s43, 0x10000000
    buffer_load_dword v207, v7, s[20:23], s49 offen sc1
    s_branch A_b2_78
A_rs_81:
    s_mov_b32 exec_hi, 0
    v_xor_b32 v212, s46, v212
    v_xor_b32 v213, s46, v213
    v_xor_b32 v214, s46, v214
    v_xor_b32 v215, s46, v215
    v_or_b32 v212, v212, v213
    v_or3_b32 v212, v212, v214, v215
    v_cmp_eq_u32 vcc, 0, v212
    buffer_load_dwordx4 v[212:215], v208, s[28:31], s48 offen sc1
    s_mov_b32 exec_hi, -1
    s_lshr_b32 s6, vcc_lo, 1
    s_and_b32 s44, s6, vcc_lo
    s_branch A_b1_82
A_rf_79:
    s_cmp_eq_u32 s50, 0
    s_cbranch_scc1 A_jk_95
    s_mov_b32 s47, 200000
    s_mov_b32 exec_hi, 0
A_rp_94:
    s_waitcnt vmcnt(0)
    v_xor_b32 v212, s46, v212
    v_xor_b32 v213, s46, v213
    v_xor_b32 v214, s46, v214
    v_xor_b32 v215, s46, v215
    v_or_b32 v212, v212, v213
    v_or3_b32 v212, v212, v214, v215
    v_cmp_eq_u32 vcc, 0, v212
    buffer_load_dwordx4 v[212:215], v208, s[28:31], s48 offen sc1
    s_sub_u32 s47, s47, 1
    s_cbranch_scc1 A_jk_95
    s_lshr_b32 s6, vcc_lo, 1
    s_and_b32 s44, s6, vcc_lo
    s_and_b32 s6, s44, s50
    s_mov_b32 exec_hi, -1
    s_cbranch_scc1 A_bk_80
    s_mov_b32 exec_hi, 0
    s_sleep 2
    s_branch A_rp_94
A_jk_95:
    s_mov_b64 exec, -1
    s_mov_b32 s43, 0x10000000
    s_branch A_b2_83
ATT_slow:
    s_add_u32 s12, s80, 4194304
    s_addc_u32 s13, s81, 0
    s_mov_b32 s14, 139264
    s_mov_b32 s15, 0x20000
    v_mov_b64 v[24:25], 0
    v_mov_b64 v[26:27], 0
    v_mov_b64 v[28:29], 0
    v_mov_b64 v[30:31], 0
    v_mov_b64 v[32:33], 0
    v_mov_b64 v[34:35], 0
    v_mov_b64 v[36:37], 0
    v_mov_b64 v[38:39], 0
    v_mov_b64 v[40:41], 0
    v_mov_b64 v[42:43], 0
    v_mov_b64 v[44:45], 0
    v_mov_b64 v[46:47], 0
    v_mov_b64 v[48:49], 0
    v_mov_b64 v[50:51], 0
    v_mov_b64 v[52:53], 0
    v_mov_b64 v[54:55], 0
    v_mov_b64 v[56:57], 0
    v_mov_b64 v[58:59], 0
    v_mov_b64 v[60:61], 0
    v_mov_b64 v[62:63], 0
    v_mov_b64 v[64:65], 0
    v_mov_b64 v[66:67], 0
    v_mov_b64 v[68:69], 0
    v_mov_b64 v[70:71], 0
    v_mov_b64 v[72:73], 0
    v_mov_b64 v[74:75], 0
    v_mov_b64 v[76:77], 0
    v_mov_b64 v[78:79], 0
    v_mov_b64 v[80:81], 0
    v_mov_b64 v[82:83], 0
    v_mov_b64 v[84:85], 0
    v_mov_b64 v[86:87], 0
    s_mov_b32 s43, 0
    v_mov_b32 v220, 0xff800000
ATT_s1_96:
    buffer_load_dwordx4 v[152:155], v4, s[12:15], s43 offen sc1
    buffer_load_dwordx4 v[164:167], v4, s[12:15], s43 offen offset:1024 sc1
    s_add_u32 s43, s43, 4352
    s_waitcnt vmcnt(0)
    v_mfma_f32_32x32x16_bf16 v[88:103], v[152:155], v[8:11], 0
    v_mfma_f32_32x32x16_bf16 v[104:119], v[164:167], v[8:11], 0
    s_nop 15
    v_max3_f32 v220, v88, v89, v220
    v_max3_f32 v220, v90, v91, v220
    v_max3_f32 v220, v92, v93, v220
    v_max3_f32 v220, v94, v95, v220
    v_max3_f32 v220, v96, v97, v220
    v_max3_f32 v220, v98, v99, v220
    v_max3_f32 v220, v100, v101, v220
    v_max3_f32 v220, v102, v103, v220
    v_max3_f32 v220, v104, v105, v220
    v_max3_f32 v220, v106, v107, v220
    v_max3_f32 v220, v108, v109, v220
    v_max3_f32 v220, v110, v111, v220
    v_max3_f32 v220, v112, v113, v220
    v_max3_f32 v220, v114, v115, v220
    v_max3_f32 v220, v116, v117, v220
    v_max3_f32 v220, v118, v119, v220
    s_cmp_lt_u32 s43, 139264
    s_cbranch_scc1 ATT_s1_96
    v_mov_b32 v3, v220
    s_nop 1
    v_permlane32_swap_b32 v220, v3
    s_nop 1
    v_max_f32 v220, v220, v3
    v_sub_f32 v104, 0, v220
    v_sub_f32 v105, 0, v220
    v_sub_f32 v106, 0, v220
    v_sub_f32 v107, 0, v220
    v_sub_f32 v108, 0, v220
    v_sub_f32 v109, 0, v220
    v_sub_f32 v110, 0, v220
    v_sub_f32 v111, 0, v220
    v_sub_f32 v112, 0, v220
    v_sub_f32 v113, 0, v220
    v_sub_f32 v114, 0, v220
    v_sub_f32 v115, 0, v220
    v_sub_f32 v116, 0, v220
    v_sub_f32 v117, 0, v220
    v_sub_f32 v118, 0, v220
    v_sub_f32 v119, 0, v220
    s_mul_i32 s43, s42, 69632
    s_mov_b32 s52, 16
ATT_s2_97:
    buffer_load_dwordx4 v[152:155], v4, s[12:15], s43 offen offset:0 sc1
    buffer_load_dwordx4 v[156:159], v5, s[12:15], s43 offen offset:2048 sc1
    buffer_load_dwordx4 v[160:163], v5, s[12:15], s43 offen offset:2624 sc1
    buffer_load_dwordx4 v[164:167], v4, s[12:15], s43 offen offset:1024 sc1
    buffer_load_dwordx4 v[168:171], v5, s[12:15], s43 offen offset:3200 sc1
    buffer_load_dwordx4 v[172:175], v5, s[12:15], s43 offen offset:3776 sc1
    s_add_u32 s43, s43, 4352
    s_waitcnt vmcnt(0)
    v_mfma_f32_32x32x16_bf16 v[88:103], v[152:155], v[8:11], v[104:119]
    s_nop 15
    v_exp_f32 v88, v88
    v_exp_f32 v89, v89
    v_exp_f32 v90, v90
    v_exp_f32 v91, v91
    v_exp_f32 v92, v92
    v_exp_f32 v93, v93
    v_exp_f32 v94, v94
    v_exp_f32 v95, v95
    v_exp_f32 v96, v96
    v_exp_f32 v97, v97
    v_exp_f32 v98, v98
    v_exp_f32 v99, v99
    v_exp_f32 v100, v100
    v_exp_f32 v101, v101
    v_exp_f32 v102, v102
    v_exp_f32 v103, v103
    s_nop 1
    v_smfmac_f32_32x32x32_bf16 v[24:39], v[156:159], v[88:95], v6
    v_smfmac_f32_32x32x32_bf16 v[24:39], v[160:163], v[96:103], v6
    v_mfma_f32_32x32x16_bf16 v[88:103], v[164:167], v[8:11], v[104:119]
    s_nop 15
    v_exp_f32 v88, v88
    v_exp_f32 v89, v89
    v_exp_f32 v90, v90
    v_exp_f32 v91, v91
    v_exp_f32 v92, v92
    v_exp_f32 v93, v93
    v_exp_f32 v94, v94
    v_exp_f32 v95, v95
    v_exp_f32 v96, v96
    v_exp_f32 v97, v97
    v_exp_f32 v98, v98
    v_exp_f32 v99, v99
    v_exp_f32 v100, v100
    v_exp_f32 v101, v101
    v_exp_f32 v102, v102
    v_exp_f32 v103, v103
    s_nop 1
    v_smfmac_f32_32x32x32_bf16 v[24:39], v[168:171], v[88:95], v6
    v_smfmac_f32_32x32x32_bf16 v[24:39], v[172:175], v[96:103], v6
    s_sub_u32 s52, s52, 1
    s_cmp_lg_u32 s52, 0
    s_cbranch_scc1 ATT_s2_97
    s_mov_b32 s43, 0
    v_mov_b32 v220, 0xff800000
ATT_s1_98:
    buffer_load_dwordx4 v[152:155], v4, s[12:15], s43 offen sc1
    buffer_load_dwordx4 v[164:167], v4, s[12:15], s43 offen offset:1024 sc1
    s_add_u32 s43, s43, 4352
    s_waitcnt vmcnt(0)
    v_mfma_f32_32x32x16_bf16 v[88:103], v[152:155], v[12:15], 0
    v_mfma_f32_32x32x16_bf16 v[104:119], v[164:167], v[12:15], 0
    s_nop 15
    v_max3_f32 v220, v88, v89, v220
    v_max3_f32 v220, v90, v91, v220
    v_max3_f32 v220, v92, v93, v220
    v_max3_f32 v220, v94, v95, v220
    v_max3_f32 v220, v96, v97, v220
    v_max3_f32 v220, v98, v99, v220
    v_max3_f32 v220, v100, v101, v220
    v_max3_f32 v220, v102, v103, v220
    v_max3_f32 v220, v104, v105, v220
    v_max3_f32 v220, v106, v107, v220
    v_max3_f32 v220, v108, v109, v220
    v_max3_f32 v220, v110, v111, v220
    v_max3_f32 v220, v112, v113, v220
    v_max3_f32 v220, v114, v115, v220
    v_max3_f32 v220, v116, v117, v220
    v_max3_f32 v220, v118, v119, v220
    s_cmp_lt_u32 s43, 139264
    s_cbranch_scc1 ATT_s1_98
    v_mov_b32 v3, v220
    s_nop 1
    v_permlane32_swap_b32 v220, v3
    s_nop 1
    v_max_f32 v220, v220, v3
    v_sub_f32 v104, 0, v220
    v_sub_f32 v105, 0, v220
    v_sub_f32 v106, 0, v220
    v_sub_f32 v107, 0, v220
    v_sub_f32 v108, 0, v220
    v_sub_f32 v109, 0, v220
    v_sub_f32 v110, 0, v220
    v_sub_f32 v111, 0, v220
    v_sub_f32 v112, 0, v220
    v_sub_f32 v113, 0, v220
    v_sub_f32 v114, 0, v220
    v_sub_f32 v115, 0, v220
    v_sub_f32 v116, 0, v220
    v_sub_f32 v117, 0, v220
    v_sub_f32 v118, 0, v220
    v_sub_f32 v119, 0, v220
    s_mul_i32 s43, s42, 69632
    s_mov_b32 s52, 16
ATT_s2_99:
    buffer_load_dwordx4 v[152:155], v4, s[12:15], s43 offen offset:0 sc1
    buffer_load_dwordx4 v[156:159], v5, s[12:15], s43 offen offset:2048 sc1
    buffer_load_dwordx4 v[160:163], v5, s[12:15], s43 offen offset:2624 sc1
    buffer_load_dwordx4 v[164:167], v4, s[12:15], s43 offen offset:1024 sc1
    buffer_load_dwordx4 v[168:171], v5, s[12:15], s43 offen offset:3200 sc1
    buffer_load_dwordx4 v[172:175], v5, s[12:15], s43 offen offset:3776 sc1
    s_add_u32 s43, s43, 4352
    s_waitcnt vmcnt(0)
    v_mfma_f32_32x32x16_bf16 v[88:103], v[152:155], v[12:15], v[104:119]
    s_nop 15
    v_exp_f32 v88, v88
    v_exp_f32 v89, v89
    v_exp_f32 v90, v90
    v_exp_f32 v91, v91
    v_exp_f32 v92, v92
    v_exp_f32 v93, v93
    v_exp_f32 v94, v94
    v_exp_f32 v95, v95
    v_exp_f32 v96, v96
    v_exp_f32 v97, v97
    v_exp_f32 v98, v98
    v_exp_f32 v99, v99
    v_exp_f32 v100, v100
    v_exp_f32 v101, v101
    v_exp_f32 v102, v102
    v_exp_f32 v103, v103
    s_nop 1
    v_smfmac_f32_32x32x32_bf16 v[40:55], v[156:159], v[88:95], v6
    v_smfmac_f32_32x32x32_bf16 v[40:55], v[160:163], v[96:103], v6
    v_mfma_f32_32x32x16_bf16 v[88:103], v[164:167], v[12:15], v[104:119]
    s_nop 15
    v_exp_f32 v88, v88
    v_exp_f32 v89, v89
    v_exp_f32 v90, v90
    v_exp_f32 v91, v91
    v_exp_f32 v92, v92
    v_exp_f32 v93, v93
    v_exp_f32 v94, v94
    v_exp_f32 v95, v95
    v_exp_f32 v96, v96
    v_exp_f32 v97, v97
    v_exp_f32 v98, v98
    v_exp_f32 v99, v99
    v_exp_f32 v100, v100
    v_exp_f32 v101, v101
    v_exp_f32 v102, v102
    v_exp_f32 v103, v103
    s_nop 1
    v_smfmac_f32_32x32x32_bf16 v[40:55], v[168:171], v[88:95], v6
    v_smfmac_f32_32x32x32_bf16 v[40:55], v[172:175], v[96:103], v6
    s_sub_u32 s52, s52, 1
    s_cmp_lg_u32 s52, 0
    s_cbranch_scc1 ATT_s2_99
    s_mov_b32 s43, 0
    v_mov_b32 v220, 0xff800000
ATT_s1_100:
    buffer_load_dwordx4 v[152:155], v4, s[12:15], s43 offen sc1
    buffer_load_dwordx4 v[164:167], v4, s[12:15], s43 offen offset:1024 sc1
    s_add_u32 s43, s43, 4352
    s_waitcnt vmcnt(0)
    v_mfma_f32_32x32x16_bf16 v[88:103], v[152:155], v[16:19], 0
    v_mfma_f32_32x32x16_bf16 v[104:119], v[164:167], v[16:19], 0
    s_nop 15
    v_max3_f32 v220, v88, v89, v220
    v_max3_f32 v220, v90, v91, v220
    v_max3_f32 v220, v92, v93, v220
    v_max3_f32 v220, v94, v95, v220
    v_max3_f32 v220, v96, v97, v220
    v_max3_f32 v220, v98, v99, v220
    v_max3_f32 v220, v100, v101, v220
    v_max3_f32 v220, v102, v103, v220
    v_max3_f32 v220, v104, v105, v220
    v_max3_f32 v220, v106, v107, v220
    v_max3_f32 v220, v108, v109, v220
    v_max3_f32 v220, v110, v111, v220
    v_max3_f32 v220, v112, v113, v220
    v_max3_f32 v220, v114, v115, v220
    v_max3_f32 v220, v116, v117, v220
    v_max3_f32 v220, v118, v119, v220
    s_cmp_lt_u32 s43, 139264
    s_cbranch_scc1 ATT_s1_100
    v_mov_b32 v3, v220
    s_nop 1
    v_permlane32_swap_b32 v220, v3
    s_nop 1
    v_max_f32 v220, v220, v3
    v_sub_f32 v104, 0, v220
    v_sub_f32 v105, 0, v220
    v_sub_f32 v106, 0, v220
    v_sub_f32 v107, 0, v220
    v_sub_f32 v108, 0, v220
    v_sub_f32 v109, 0, v220
    v_sub_f32 v110, 0, v220
    v_sub_f32 v111, 0, v220
    v_sub_f32 v112, 0, v220
    v_sub_f32 v113, 0, v220
    v_sub_f32 v114, 0, v220
    v_sub_f32 v115, 0, v220
    v_sub_f32 v116, 0, v220
    v_sub_f32 v117, 0, v220
    v_sub_f32 v118, 0, v220
    v_sub_f32 v119, 0, v220
    s_mul_i32 s43, s42, 69632
    s_mov_b32 s52, 16
ATT_s2_101:
    buffer_load_dwordx4 v[152:155], v4, s[12:15], s43 offen offset:0 sc1
    buffer_load_dwordx4 v[156:159], v5, s[12:15], s43 offen offset:2048 sc1
    buffer_load_dwordx4 v[160:163], v5, s[12:15], s43 offen offset:2624 sc1
    buffer_load_dwordx4 v[164:167], v4, s[12:15], s43 offen offset:1024 sc1
    buffer_load_dwordx4 v[168:171], v5, s[12:15], s43 offen offset:3200 sc1
    buffer_load_dwordx4 v[172:175], v5, s[12:15], s43 offen offset:3776 sc1
    s_add_u32 s43, s43, 4352
    s_waitcnt vmcnt(0)
    v_mfma_f32_32x32x16_bf16 v[88:103], v[152:155], v[16:19], v[104:119]
    s_nop 15
    v_exp_f32 v88, v88
    v_exp_f32 v89, v89
    v_exp_f32 v90, v90
    v_exp_f32 v91, v91
    v_exp_f32 v92, v92
    v_exp_f32 v93, v93
    v_exp_f32 v94, v94
    v_exp_f32 v95, v95
    v_exp_f32 v96, v96
    v_exp_f32 v97, v97
    v_exp_f32 v98, v98
    v_exp_f32 v99, v99
    v_exp_f32 v100, v100
    v_exp_f32 v101, v101
    v_exp_f32 v102, v102
    v_exp_f32 v103, v103
    s_nop 1
    v_smfmac_f32_32x32x32_bf16 v[56:71], v[156:159], v[88:95], v6
    v_smfmac_f32_32x32x32_bf16 v[56:71], v[160:163], v[96:103], v6
    v_mfma_f32_32x32x16_bf16 v[88:103], v[164:167], v[16:19], v[104:119]
    s_nop 15
    v_exp_f32 v88, v88
    v_exp_f32 v89, v89
    v_exp_f32 v90, v90
    v_exp_f32 v91, v91
    v_exp_f32 v92, v92
    v_exp_f32 v93, v93
    v_exp_f32 v94, v94
    v_exp_f32 v95, v95
    v_exp_f32 v96, v96
    v_exp_f32 v97, v97
    v_exp_f32 v98, v98
    v_exp_f32 v99, v99
    v_exp_f32 v100, v100
    v_exp_f32 v101, v101
    v_exp_f32 v102, v102
    v_exp_f32 v103, v103
    s_nop 1
    v_smfmac_f32_32x32x32_bf16 v[56:71], v[168:171], v[88:95], v6
    v_smfmac_f32_32x32x32_bf16 v[56:71], v[172:175], v[96:103], v6
    s_sub_u32 s52, s52, 1
    s_cmp_lg_u32 s52, 0
    s_cbranch_scc1 ATT_s2_101
    s_mov_b32 s43, 0
    v_mov_b32 v220, 0xff800000
ATT_s1_102:
    buffer_load_dwordx4 v[152:155], v4, s[12:15], s43 offen sc1
    buffer_load_dwordx4 v[164:167], v4, s[12:15], s43 offen offset:1024 sc1
    s_add_u32 s43, s43, 4352
    s_waitcnt vmcnt(0)
    v_mfma_f32_32x32x16_bf16 v[88:103], v[152:155], v[20:23], 0
    v_mfma_f32_32x32x16_bf16 v[104:119], v[164:167], v[20:23], 0
    s_nop 15
    v_max3_f32 v220, v88, v89, v220
    v_max3_f32 v220, v90, v91, v220
    v_max3_f32 v220, v92, v93, v220
    v_max3_f32 v220, v94, v95, v220
    v_max3_f32 v220, v96, v97, v220
    v_max3_f32 v220, v98, v99, v220
    v_max3_f32 v220, v100, v101, v220
    v_max3_f32 v220, v102, v103, v220
    v_max3_f32 v220, v104, v105, v220
    v_max3_f32 v220, v106, v107, v220
    v_max3_f32 v220, v108, v109, v220
    v_max3_f32 v220, v110, v111, v220
    v_max3_f32 v220, v112, v113, v220
    v_max3_f32 v220, v114, v115, v220
    v_max3_f32 v220, v116, v117, v220
    v_max3_f32 v220, v118, v119, v220
    s_cmp_lt_u32 s43, 139264
    s_cbranch_scc1 ATT_s1_102
    v_mov_b32 v3, v220
    s_nop 1
    v_permlane32_swap_b32 v220, v3
    s_nop 1
    v_max_f32 v220, v220, v3
    v_sub_f32 v104, 0, v220
    v_sub_f32 v105, 0, v220
    v_sub_f32 v106, 0, v220
    v_sub_f32 v107, 0, v220
    v_sub_f32 v108, 0, v220
    v_sub_f32 v109, 0, v220
    v_sub_f32 v110, 0, v220
    v_sub_f32 v111, 0, v220
    v_sub_f32 v112, 0, v220
    v_sub_f32 v113, 0, v220
    v_sub_f32 v114, 0, v220
    v_sub_f32 v115, 0, v220
    v_sub_f32 v116, 0, v220
    v_sub_f32 v117, 0, v220
    v_sub_f32 v118, 0, v220
    v_sub_f32 v119, 0, v220
    s_mul_i32 s43, s42, 69632
    s_mov_b32 s52, 16
ATT_s2_103:
    buffer_load_dwordx4 v[152:155], v4, s[12:15], s43 offen offset:0 sc1
    buffer_load_dwordx4 v[156:159], v5, s[12:15], s43 offen offset:2048 sc1
    buffer_load_dwordx4 v[160:163], v5, s[12:15], s43 offen offset:2624 sc1
    buffer_load_dwordx4 v[164:167], v4, s[12:15], s43 offen offset:1024 sc1
    buffer_load_dwordx4 v[168:171], v5, s[12:15], s43 offen offset:3200 sc1
    buffer_load_dwordx4 v[172:175], v5, s[12:15], s43 offen offset:3776 sc1
    s_add_u32 s43, s43, 4352
    s_waitcnt vmcnt(0)
    v_mfma_f32_32x32x16_bf16 v[88:103], v[152:155], v[20:23], v[104:119]
    s_nop 15
    v_exp_f32 v88, v88
    v_exp_f32 v89, v89
    v_exp_f32 v90, v90
    v_exp_f32 v91, v91
    v_exp_f32 v92, v92
    v_exp_f32 v93, v93
    v_exp_f32 v94, v94
    v_exp_f32 v95, v95
    v_exp_f32 v96, v96
    v_exp_f32 v97, v97
    v_exp_f32 v98, v98
    v_exp_f32 v99, v99
    v_exp_f32 v100, v100
    v_exp_f32 v101, v101
    v_exp_f32 v102, v102
    v_exp_f32 v103, v103
    s_nop 1
    v_smfmac_f32_32x32x32_bf16 v[72:87], v[156:159], v[88:95], v6
    v_smfmac_f32_32x32x32_bf16 v[72:87], v[160:163], v[96:103], v6
    v_mfma_f32_32x32x16_bf16 v[88:103], v[164:167], v[20:23], v[104:119]
    s_nop 15
    v_exp_f32 v88, v88
    v_exp_f32 v89, v89
    v_exp_f32 v90, v90
    v_exp_f32 v91, v91
    v_exp_f32 v92, v92
    v_exp_f32 v93, v93
    v_exp_f32 v94, v94
    v_exp_f32 v95, v95
    v_exp_f32 v96, v96
    v_exp_f32 v97, v97
    v_exp_f32 v98, v98
    v_exp_f32 v99, v99
    v_exp_f32 v100, v100
    v_exp_f32 v101, v101
    v_exp_f32 v102, v102
    v_exp_f32 v103, v103
    s_nop 1
    v_smfmac_f32_32x32x32_bf16 v[72:87], v[168:171], v[88:95], v6
    v_smfmac_f32_32x32x32_bf16 v[72:87], v[172:175], v[96:103], v6
    s_sub_u32 s52, s52, 1
    s_cmp_lg_u32 s52, 0
    s_cbranch_scc1 ATT_s2_103
    s_mov_b32 s53, 3
    s_mov_b32 s54, 3
    s_nop 10
    s_branch ATT_epi
.section .rodata,"a"
.p2align 6
.amdhsa_kernel gated_mix__grouped_kv_mqa__geglu_ffn__prompt_kernel
  .amdhsa_next_free_vgpr 256
  .amdhsa_next_free_sgpr 102
  .amdhsa_accum_offset 256
  .amdhsa_group_segment_fixed_size 0
  .amdhsa_kernarg_size 104
  .amdhsa_user_sgpr_count 2
  .amdhsa_user_sgpr_kernarg_segment_ptr 1
  .amdhsa_system_sgpr_workgroup_id_x 1
.end_amdhsa_kernel
```
